```python
import torch

def _softmax(x, axis=-1):
    return torch.softmax(x, dim=axis)

def _gelu(x):
    return torch.nn.functional.gelu(x, approximate='tanh')

def _silu(x):
    return torch.nn.functional.silu(x)

def _sigmoid(x):
    return torch.sigmoid(x)

def _layernorm(x, axis=-1, eps=1e-05):
    m = x.mean(dim=axis, keepdim=True)
    v = x.var(dim=axis, keepdim=True, unbiased=False)
    return (x - m) / torch.sqrt(v + eps)

def _scatter_add(tgt, idx, src, axis=0):
    return tgt.clone().index_add_(axis, idx, src)

def _segment_sum(src, seg, n):
    out = torch.zeros((n,) + src.shape[1:], dtype=src.dtype)
    return out.index_add_(0, seg, src)

def _pad(x, pw):
    flat = tuple((v for pair in reversed(pw) for v in pair))
    return torch.nn.functional.pad(x, flat)
kernel_name = 'standalone__molecular_angular_painn__graph'

def setup_inputs():

    _w = lambda a: (lambda t: t.to(torch.bfloat16) if t.is_floating_point() else t)(torch.as_tensor(a))
    N, deg, D = (12500, 32, 128)
    n_rbf = max(16, 4)
    E = N * deg
    cutoff = 5.0
    freqs = (torch.arange(1, n_rbf + 1) * torch.pi / cutoff).to(float)
    return {'sv': _w((lambda *s: torch.randn(*s, dtype=torch.bfloat16) * 0.4)(N, 4, D) * 0.3), 'pos': _w((lambda *s: torch.randn(*s, dtype=torch.bfloat16) * 1.6)(N, 3) * 1.2), 'src': _w((lambda lo, hi, *s: torch.randint(lo, hi, s))(0, N, E).to(torch.int64)), 'dst': _w((lambda lo, hi, *s: torch.randint(lo, hi, s))(0, N, E).to(torch.int64)), 'freqs': _w(freqs), 'w_phi1': _w((lambda *s: torch.randn(*s, dtype=torch.bfloat16) * 3.2)(D, D) / D ** 0.5), 'w_phi2': _w((lambda *s: torch.randn(*s, dtype=torch.bfloat16) * 1.6)(D, 3 * D) / D ** 0.5), 'w_rbf': _w((lambda *s: torch.randn(*s, dtype=torch.bfloat16) * 1.6)(n_rbf, 3 * D) / n_rbf ** 0.5)}

def reference(sv, pos, src, dst, freqs, w_phi1, w_phi2, w_rbf):
    N, _, D = sv.shape
    E = src.shape[0]
    PI, cutoff = (3.141592653589793, 5.0)
    s, v = (sv[:, 0, :].clone(), sv[:, 1:, :].clone())
    r_vec = pos[src] - pos[dst]
    d = torch.sqrt((r_vec * r_vec).sum(-1) + 1e-08)
    r_hat = r_vec / d[:, None]
    rbf = torch.sin(d[:, None] * freqs[None, :]) / d[:, None]
    fcut = 0.5 * (torch.cos(PI * d / cutoff) + 1.0)
    fcut = torch.where(d < cutoff, fcut, 0.0 * d)
    Wf = rbf @ w_rbf * fcut[:, None]
    phi = (_silu(s @ w_phi1) @ w_phi2)[src]
    m = phi * Wf
    m_s, m_vv, m_vr = (m[:, :D].clone(), m[:, D:2 * D].clone(), m[:, 2 * D:].clone())
    ds = _segment_sum(m_s, dst, N)
    dv_e = m_vv[:, None, :] * v[src] + m_vr[:, None, :] * r_hat[:, :, None]
    dv = _segment_sum(dv_e.reshape(E, 3 * D), dst, N).reshape(N, 3, D)
    return sv + torch.concatenate([ds[:, None, :], dv], axis=1)
```

```asm
; @launch grid=(256,1,1) block=(1024,1,1) lds=163840
.amdgcn_target "amdgcn-amd-amdhsa--gfx950"
.text
.globl standalone__molecular_angular_painn__graph_kernel
.type standalone__molecular_angular_painn__graph_kernel,@function
.p2align 8
standalone__molecular_angular_painn__graph_kernel:
    s_cmp_ge_u32 s2, 256
    s_cbranch_scc1 K_END
    s_getpc_b64 s[4:5]
CODE0:
    v_lshlrev_b32 v2, 5, v0
    v_min_u32 v2, CODE1-CODE0-16, v2
    v_mov_b32 v3, s5
    v_add_co_u32 v2, vcc, s4, v2
    s_nop 1
    v_addc_co_u32 v3, vcc, 0, v3, vcc
    global_load_dword v4, v[2:3], off
    s_load_dwordx16 s[64:79], s[0:1], 0
    s_load_dwordx4 s[80:83], s[0:1], 64
    s_load_dwordx2 s[32:33], s[0:1], 80
    v_lshrrev_b32 v1, 6, v0
    s_nop 0
    v_readfirstlane_b32 s48, v1
    v_and_b32 v1, 63, v0
    s_bfe_u32 s49, s2, 0x20001
    s_and_b32 s3, s2, 1
    s_lshl_b32 s3, s3, 5
    s_lshr_b32 s94, s2, 3
    s_or_b32 s50, s94, s3
    s_mul_i32 s96, s50, 196
    s_mul_i32 s92, s49, 49
    s_add_u32 s92, s92, s96
    v_lshlrev_b32 v5, 2, v0
    v_mov_b32 v6, 0
    v_cmp_gt_u32 vcc, 640, v0
    s_nop 0
    s_mov_b64 exec, vcc
    ds_write_b32 v5, v6
    s_mov_b64 exec, -1
    v_lshlrev_b32 v7, 4, v1
    v_and_b32 v12, 3, v0
    v_lshlrev_b32 v12, 3, v12
    v_and_b32 v8, 15, v1
    v_lshrrev_b32 v9, 4, v1
    s_waitcnt lgkmcnt(0)
    s_barrier
    s_mov_b32 s12, s64
    s_mov_b32 s13, s65
    s_mov_b32 s14, 0xc35000
    s_mov_b32 s15, 0x20000
    s_mov_b32 s44, s82
    s_mov_b32 s45, s83
    s_mov_b32 s46, 0x100
    s_mov_b32 s47, 0x20000
    s_add_u32 s20, s32, 0xf50000
    s_addc_u32 s21, s33, 0
    s_mov_b32 s22, 0x4c8000
    s_mov_b32 s23, 0x20000
    s_cmp_lt_u32 s48, 8
    s_cbranch_scc1 A_E
    s_mov_b32 s36, s74
    s_mov_b32 s37, s75
    s_mov_b32 s38, 0x8000
    s_mov_b32 s39, 0x20000
    s_mov_b32 s40, s76
    s_mov_b32 s41, s77
    s_mov_b32 s42, 0x18000
    s_mov_b32 s43, 0x20000
    s_xor_b32 s3, s48, 15
    s_or_b32 s3, s3, s2
    s_cmp_lg_u32 s3, 0
    s_cbranch_scc1 A_NON
    s_memrealtime s[0:1]
    s_waitcnt lgkmcnt(0)
    s_or_b32 s3, s0, 1
    v_mov_b32 v10, s3
    s_mov_b64 exec, 1
    buffer_store_dword v10, v6, s[44:47], 0 offen sc0 sc1
    s_mov_b64 exec, -1
A_NON:
    s_sub_u32 s95, s48, 8
    s_cmp_ge_u32 s48, 13
    s_cbranch_scc1 A_X0
    v_lshlrev_b32 v10, 10, v9
    v_lshl_add_u32 v10, v8, 4, v10
    s_lshl_b32 s3, s95, 2
    s_add_u32 s3, s3, s96
    s_lshl_b32 s3, s3, 10
    buffer_load_dwordx4 v[64:67], v10, s[12:15], s3 offen
    s_add_u32 s3, s3, 20480
    buffer_load_dwordx4 v[68:71], v10, s[12:15], s3 offen
    s_add_u32 s3, s3, 20480
    buffer_load_dwordx4 v[72:75], v10, s[12:15], s3 offen
    s_add_u32 s3, s3, 20480
    buffer_load_dwordx4 v[76:79], v10, s[12:15], s3 offen
    s_add_u32 s3, s3, 20480
    buffer_load_dwordx4 v[80:83], v10, s[12:15], s3 offen
    s_add_u32 s3, s3, 20480
    buffer_load_dwordx4 v[84:87], v10, s[12:15], s3 offen
    s_add_u32 s3, s3, 20480
    buffer_load_dwordx4 v[88:91], v10, s[12:15], s3 offen
    s_add_u32 s3, s3, 20480
    buffer_load_dwordx4 v[92:95], v10, s[12:15], s3 offen
    s_add_u32 s3, s3, 20480
    buffer_load_dwordx4 v[96:99], v10, s[12:15], s3 offen
    s_add_u32 s3, s3, 20480
    buffer_load_dwordx4 v[100:103], v10, s[12:15], s3 offen
    s_add_u32 s3, s3, 20480
    v_lshlrev_b32 v11, 5, v9
    v_xor_b32 v11, v11, v7
    s_add_u32 s93, s94, s95
    s_and_b32 s3, s93, 31
    s_lshl_b32 s92, s3, 6
    s_and_b32 s92, s92, 128
    v_xor_b32 v13, s92, v11
    s_lshl_b32 s3, s3, 10
    s_add_u32 m0, s3, 31488
    s_nop 0
    buffer_load_dwordx4 v13, s[36:39], s3 offen lds
    s_add_u32 s93, s93, 5
    s_and_b32 s3, s93, 31
    s_lshl_b32 s92, s3, 6
    s_and_b32 s92, s92, 128
    v_xor_b32 v13, s92, v11
    s_lshl_b32 s3, s3, 10
    s_add_u32 m0, s3, 31488
    s_nop 0
    buffer_load_dwordx4 v13, s[36:39], s3 offen lds
    s_add_u32 s93, s93, 5
    s_and_b32 s3, s93, 31
    s_lshl_b32 s92, s3, 6
    s_and_b32 s92, s92, 128
    v_xor_b32 v13, s92, v11
    s_lshl_b32 s3, s3, 10
    s_add_u32 m0, s3, 31488
    s_nop 0
    buffer_load_dwordx4 v13, s[36:39], s3 offen lds
    s_add_u32 s93, s93, 5
    s_and_b32 s3, s93, 31
    s_lshl_b32 s92, s3, 6
    s_and_b32 s92, s92, 128
    v_xor_b32 v13, s92, v11
    s_lshl_b32 s3, s3, 10
    s_add_u32 m0, s3, 31488
    s_nop 0
    buffer_load_dwordx4 v13, s[36:39], s3 offen lds
    s_add_u32 s93, s93, 5
    s_and_b32 s3, s93, 31
    s_lshl_b32 s92, s3, 6
    s_and_b32 s92, s92, 128
    v_xor_b32 v13, s92, v11
    s_lshl_b32 s3, s3, 10
    s_add_u32 m0, s3, 31488
    s_nop 0
    buffer_load_dwordx4 v13, s[36:39], s3 offen lds
    s_add_u32 s93, s93, 5
    s_and_b32 s3, s93, 31
    s_lshl_b32 s92, s3, 6
    s_and_b32 s92, s92, 128
    v_xor_b32 v13, s92, v11
    s_lshl_b32 s3, s3, 10
    s_add_u32 m0, s3, 31488
    s_nop 0
    buffer_load_dwordx4 v13, s[36:39], s3 offen lds
    s_add_u32 s93, s93, 5
    s_and_b32 s3, s93, 31
    s_lshl_b32 s92, s3, 6
    s_and_b32 s92, s92, 128
    v_xor_b32 v13, s92, v11
    s_lshl_b32 s3, s3, 10
    s_add_u32 m0, s3, 31488
    s_nop 0
    buffer_load_dwordx4 v13, s[36:39], s3 offen lds
    s_add_u32 s93, s93, 5
    v_lshrrev_b32 v13, 2, v1
    v_and_b32 v14, 3, v1
    v_mul_u32_u24 v15, 768, v13
    v_lshl_add_u32 v15, v14, 4, v15
    s_lshl_b32 s94, s49, 6
    s_add_u32 s93, s95, 0
    s_min_u32 s93, s93, 23
    s_and_b32 s3, s93, 7
    s_lshr_b32 s93, s93, 3
    s_mul_i32 s92, s3, 3072
    s_lshl_b32 s3, s93, 6
    s_add_u32 s92, s92, s3
    v_writelane_b32 v60, s92, 0
    s_lshl_b32 s92, s92, 2
    s_add_u32 s92, s92, s94
    buffer_load_dwordx4 v[16:19], v15, s[40:43], s92 offen
    s_add_u32 s93, s95, 5
    s_min_u32 s93, s93, 23
    s_and_b32 s3, s93, 7
    s_lshr_b32 s93, s93, 3
    s_mul_i32 s92, s3, 3072
    s_lshl_b32 s3, s93, 6
    s_add_u32 s92, s92, s3
    v_writelane_b32 v60, s92, 1
    s_lshl_b32 s92, s92, 2
    s_add_u32 s92, s92, s94
    buffer_load_dwordx4 v[20:23], v15, s[40:43], s92 offen
    s_add_u32 s93, s95, 10
    s_min_u32 s93, s93, 23
    s_and_b32 s3, s93, 7
    s_lshr_b32 s93, s93, 3
    s_mul_i32 s92, s3, 3072
    s_lshl_b32 s3, s93, 6
    s_add_u32 s92, s92, s3
    v_writelane_b32 v60, s92, 2
    s_lshl_b32 s92, s92, 2
    s_add_u32 s92, s92, s94
    buffer_load_dwordx4 v[24:27], v15, s[40:43], s92 offen
    s_add_u32 s93, s95, 15
    s_min_u32 s93, s93, 23
    s_and_b32 s3, s93, 7
    s_lshr_b32 s93, s93, 3
    s_mul_i32 s92, s3, 3072
    s_lshl_b32 s3, s93, 6
    s_add_u32 s92, s92, s3
    v_writelane_b32 v60, s92, 3
    s_lshl_b32 s92, s92, 2
    s_add_u32 s92, s92, s94
    buffer_load_dwordx4 v[28:31], v15, s[40:43], s92 offen
    s_add_u32 s93, s95, 20
    s_min_u32 s93, s93, 23
    s_and_b32 s3, s93, 7
    s_lshr_b32 s93, s93, 3
    s_mul_i32 s92, s3, 3072
    s_lshl_b32 s3, s93, 6
    s_add_u32 s92, s92, s3
    v_writelane_b32 v60, s92, 4
    s_lshl_b32 s92, s92, 2
    s_add_u32 s92, s92, s94
    buffer_load_dwordx4 v[32:35], v15, s[40:43], s92 offen
    v_mov_b32 v126, 2360
    v_mov_b32 v127, 1
    s_mov_b64 exec, 1
    ds_add_u32 v126, v127
    s_mov_b64 exec, -1
    s_mov_b32 s16, s80
    s_mov_b32 s17, s81
    s_mov_b32 s18, 0xc35000
    s_mov_b32 s19, 0x20000
    s_add_u32 s28, s32, 0x1418000
    s_addc_u32 s29, s33, 0
    s_mov_b32 s30, 0x1880000
    s_mov_b32 s31, 0x20000
    s_mul_i32 s3, s49, 3211264
    s_add_u32 s4, s32, s3
    s_addc_u32 s5, s33, 0
    s_mov_b32 s6, 0x30d400
    s_mov_b32 s7, 0x20000
    s_lshr_b32 s3, s49, 1
    s_lshl_b32 s24, s3, 7
    s_mul_i32 s3, s3, 1605632
    s_add_u32 s3, s3, 12845056
    s_add_u32 s8, s32, s3
    s_addc_u32 s9, s33, 0
    s_mov_b32 s10, 0x186a00
    s_mov_b32 s11, 0x20000
    s_mov_b32 s51, 0
    s_mov_b32 s52, 48
    s_mov_b32 s54, 1
    s_mov_b64 s[34:35], s[78:79]
    s_mov_b32 s90, 0x05040100
    s_mov_b32 s91, 0x07060302
    v_mul_u32_u24 v15, 192, v13
    v_lshl_add_u32 v15, v14, 3, v15
    v_add_u32 v15, 64256, v15
    v_and_b32 v14, 4, v13
    v_lshlrev_b32 v14, 3, v14
    v_add_u32 v12, v15, v14
    v_xor_b32 v14, 32, v14
    v_add_u32 v13, v15, v14
    v_xor_b32 v14, v8, v9
    v_lshlrev_b32 v14, 4, v14
    v_lshl_add_u32 v14, v9, 8, v14
    s_lshl_b32 s3, s95, 10
    s_add_u32 s3, s3, 109312
    v_add_u32 v14, s3, v14
    s_lshl_b32 s93, s95, 6
    v_mov_b32 v11, 2324
A_HWL:
    ds_read_b32 v10, v11
    s_waitcnt lgkmcnt(0)
    v_readfirstlane_b32 s3, v10
    s_nop 0
    s_cmp_ge_u32 s3, 8
    s_cbranch_scc1 A_HWL_OK
    s_sleep 1
    s_branch A_HWL
A_HWL_OK:
    s_setprio 3
    s_and_b32 s3, s93, 192
    v_xor_b32 v10, s3, v14
    s_waitcnt vmcnt(21)
    ds_write_b128 v10, v[64:67] offset:0
    s_add_u32 s93, s93, 64
    s_and_b32 s3, s93, 192
    v_xor_b32 v11, s3, v14
    s_waitcnt vmcnt(20)
    ds_write_b128 v11, v[68:71] offset:5120
    s_add_u32 s93, s93, 64
    s_and_b32 s3, s93, 192
    v_xor_b32 v10, s3, v14
    s_waitcnt vmcnt(19)
    ds_write_b128 v10, v[72:75] offset:10240
    s_add_u32 s93, s93, 64
    s_and_b32 s3, s93, 192
    v_xor_b32 v11, s3, v14
    s_waitcnt vmcnt(18)
    ds_write_b128 v11, v[76:79] offset:15360
    s_add_u32 s93, s93, 64
    s_and_b32 s3, s93, 192
    v_xor_b32 v10, s3, v14
    s_waitcnt vmcnt(17)
    ds_write_b128 v10, v[80:83] offset:20480
    s_add_u32 s93, s93, 64
    s_and_b32 s3, s93, 192
    v_xor_b32 v11, s3, v14
    s_waitcnt vmcnt(16)
    ds_write_b128 v11, v[84:87] offset:25600
    s_add_u32 s93, s93, 64
    s_and_b32 s3, s93, 192
    v_xor_b32 v10, s3, v14
    s_waitcnt vmcnt(15)
    ds_write_b128 v10, v[88:91] offset:30720
    s_add_u32 s93, s93, 64
    s_and_b32 s3, s93, 192
    v_xor_b32 v11, s3, v14
    s_waitcnt vmcnt(14)
    ds_write_b128 v11, v[92:95] offset:35840
    s_add_u32 s93, s93, 64
    s_and_b32 s3, s93, 192
    v_xor_b32 v10, s3, v14
    s_waitcnt vmcnt(13)
    ds_write_b128 v10, v[96:99] offset:40960
    s_add_u32 s93, s93, 64
    s_and_b32 s3, s93, 192
    v_xor_b32 v11, s3, v14
    s_waitcnt vmcnt(12)
    ds_write_b128 v11, v[100:103] offset:46080
    s_add_u32 s93, s93, 64
    s_waitcnt vmcnt(5)
    v_mov_b32 v126, 2340
    v_mov_b32 v127, 1
    s_mov_b64 exec, 1
    ds_add_u32 v126, v127
    s_mov_b64 exec, -1
    s_waitcnt vmcnt(0)
    v_readlane_b32 s3, v60, 0
    v_perm_b32 v36, v17, v16, s90
    v_perm_b32 v37, v19, v18, s90
    v_perm_b32 v38, v17, v16, s91
    v_perm_b32 v39, v19, v18, s91
    v_add_u32 v10, s3, v12
    v_add_u32 v11, s3, v13
    ds_write_b64 v10, v[36:37]
    ds_write_b64 v11, v[38:39]
    v_readlane_b32 s3, v60, 1
    v_perm_b32 v40, v21, v20, s90
    v_perm_b32 v41, v23, v22, s90
    v_perm_b32 v42, v21, v20, s91
    v_perm_b32 v43, v23, v22, s91
    v_add_u32 v10, s3, v12
    v_add_u32 v11, s3, v13
    ds_write_b64 v10, v[40:41]
    ds_write_b64 v11, v[42:43]
    v_readlane_b32 s3, v60, 2
    v_perm_b32 v44, v25, v24, s90
    v_perm_b32 v45, v27, v26, s90
    v_perm_b32 v46, v25, v24, s91
    v_perm_b32 v47, v27, v26, s91
    v_add_u32 v10, s3, v12
    v_add_u32 v11, s3, v13
    ds_write_b64 v10, v[44:45]
    ds_write_b64 v11, v[46:47]
    v_readlane_b32 s3, v60, 3
    v_perm_b32 v48, v29, v28, s90
    v_perm_b32 v49, v31, v30, s90
    v_perm_b32 v50, v29, v28, s91
    v_perm_b32 v51, v31, v30, s91
    v_add_u32 v10, s3, v12
    v_add_u32 v11, s3, v13
    ds_write_b64 v10, v[48:49]
    ds_write_b64 v11, v[50:51]
    v_readlane_b32 s3, v60, 4
    v_perm_b32 v52, v33, v32, s90
    v_perm_b32 v53, v35, v34, s90
    v_perm_b32 v54, v33, v32, s91
    v_perm_b32 v55, v35, v34, s91
    v_add_u32 v10, s3, v12
    v_add_u32 v11, s3, v13
    ds_write_b64 v10, v[52:53]
    ds_write_b64 v11, v[54:55]
    v_mov_b32 v126, 2364
    v_mov_b32 v127, 1
    s_mov_b64 exec, 1
    ds_add_u32 v126, v127
    s_mov_b64 exec, -1
    s_branch A_G
A_X0:
    s_load_dwordx8 s[36:43], s[72:73], 0
    s_mov_b32 s16, s80
    s_mov_b32 s17, s81
    s_mov_b32 s18, 0xc35000
    s_mov_b32 s19, 0x20000
    s_add_u32 s28, s32, 0x1418000
    s_addc_u32 s29, s33, 0
    s_mov_b32 s30, 0x1880000
    s_mov_b32 s31, 0x20000
    s_mul_i32 s3, s49, 3211264
    s_add_u32 s4, s32, s3
    s_addc_u32 s5, s33, 0
    s_mov_b32 s6, 0x30d400
    s_mov_b32 s7, 0x20000
    s_lshr_b32 s3, s49, 1
    s_lshl_b32 s24, s3, 7
    s_mul_i32 s3, s3, 1605632
    s_add_u32 s3, s3, 12845056
    s_add_u32 s8, s32, s3
    s_addc_u32 s9, s33, 0
    s_mov_b32 s10, 0x186a00
    s_mov_b32 s11, 0x20000
    s_mov_b32 s51, 0
    s_mov_b32 s52, 48
    s_mov_b32 s54, 1
    s_mov_b64 s[34:35], s[78:79]
    s_mov_b32 s90, 0x05040100
    s_mov_b32 s91, 0x07060302
    v_subrev_u32 v44, 832, v0
    v_lshlrev_b32 v45, 3, v44
    v_lshrrev_b32 v44, 2, v44
    v_add_u32 v44, 16032, v44
    v_lshlrev_b32 v44, 16, v44
    v_lshlrev_b32 v46, 2, v1
    ds_write_b32 v46, v6 offset:23040
    v_and_b32 v10, 3, v0
    s_waitcnt lgkmcnt(0)
    v_mov_b32 v2, s36
    v_mov_b32 v3, s37
    v_cmp_eq_u32 vcc, 1, v10
    s_nop 0
    s_mov_b64 exec, vcc
    v_mov_b32 v2, s38
    v_mov_b32 v3, s39
    s_mov_b64 exec, -1
    v_cmp_eq_u32 vcc, 2, v10
    s_nop 0
    s_mov_b64 exec, vcc
    v_mov_b32 v2, s40
    v_mov_b32 v3, s41
    s_mov_b64 exec, -1
    v_cmp_eq_u32 vcc, 3, v10
    s_nop 0
    s_mov_b64 exec, vcc
    v_mov_b32 v2, s42
    v_mov_b32 v3, s43
    s_mov_b64 exec, -1
    s_setprio 1
    v_lshlrev_b32 v40, 16, v2
    v_and_b32 v41, 0xffff0000, v2
    v_lshlrev_b32 v42, 16, v3
    v_and_b32 v43, 0xffff0000, v3
    v_lshlrev_b32 v10, 4, v10
    ds_write_b128 v10, v[40:43] offset:2816
    s_mov_b32 s94, 6
    s_cmp_eq_u32 s48, 13
    s_cselect_b32 s94, 6, 5
A_GT1:
    s_cmp_eq_u32 s94, 0
    s_cbranch_scc1 A_GT1_D
    v_mov_b32 v39, 2320
    ds_read_b32 v39, v39
    v_add_u32 v38, 0x1000000, v44
    v_rcp_f32 v48, v44
    v_rcp_f32 v56, v38
    v_mul_f32 v49, 0x40490fdb, v44
    v_mul_f32 v57, 0x40490fdb, v38
    v_mul_f32 v50, v40, v44
    v_mul_f32 v58, v40, v38
    v_mul_f32 v51, v41, v44
    v_mul_f32 v59, v41, v38
    v_mul_f32 v52, v42, v44
    v_mul_f32 v60, v42, v38
    v_mul_f32 v53, v43, v44
    v_mul_f32 v61, v43, v38
    v_cvt_pk_bf16_f32 v49, 0, v49
    v_cvt_pk_bf16_f32 v57, 0, v57
    v_cvt_pk_bf16_f32 v50, 0, v50
    v_cvt_pk_bf16_f32 v58, 0, v58
    v_cvt_pk_bf16_f32 v51, 0, v51
    v_cvt_pk_bf16_f32 v59, 0, v59
    v_cvt_pk_bf16_f32 v52, 0, v52
    v_cvt_pk_bf16_f32 v60, 0, v60
    v_cvt_pk_bf16_f32 v53, 0, v53
    v_cvt_pk_bf16_f32 v61, 0, v61
    v_mul_f32 v49, 0x3e4ccccd, v49
    v_mul_f32 v57, 0x3e4ccccd, v57
    v_mul_f32 v50, 0.15915494, v50
    v_mul_f32 v58, 0.15915494, v58
    v_mul_f32 v51, 0.15915494, v51
    v_mul_f32 v59, 0.15915494, v59
    v_mul_f32 v52, 0.15915494, v52
    v_mul_f32 v60, 0.15915494, v60
    v_mul_f32 v53, 0.15915494, v53
    v_mul_f32 v61, 0.15915494, v61
    v_cvt_pk_bf16_f32 v49, 0, v49
    v_cvt_pk_bf16_f32 v57, 0, v57
    v_rndne_f32 v54, v50
    v_rndne_f32 v62, v58
    v_sub_f32 v50, v50, v54
    v_sub_f32 v58, v58, v62
    v_rndne_f32 v54, v51
    v_rndne_f32 v62, v59
    v_sub_f32 v51, v51, v54
    v_sub_f32 v59, v59, v62
    v_rndne_f32 v54, v52
    v_rndne_f32 v62, v60
    v_sub_f32 v52, v52, v54
    v_sub_f32 v60, v60, v62
    v_rndne_f32 v54, v53
    v_rndne_f32 v62, v61
    v_sub_f32 v53, v53, v54
    v_sub_f32 v61, v61, v62
    v_mul_f32 v49, 0.15915494, v49
    v_mul_f32 v57, 0.15915494, v57
    v_cos_f32 v49, v49
    v_cos_f32 v57, v57
    v_sin_f32 v50, v50
    v_sin_f32 v58, v58
    v_sin_f32 v51, v51
    v_sin_f32 v59, v59
    v_sin_f32 v52, v52
    v_sin_f32 v60, v60
    v_sin_f32 v53, v53
    v_sin_f32 v61, v61
    v_cvt_pk_bf16_f32 v49, 0, v49
    v_cvt_pk_bf16_f32 v57, 0, v57
    v_cvt_pk_bf16_f32 v50, 0, v50
    v_cvt_pk_bf16_f32 v58, 0, v58
    v_cvt_pk_bf16_f32 v51, 0, v51
    v_cvt_pk_bf16_f32 v59, 0, v59
    v_cvt_pk_bf16_f32 v52, 0, v52
    v_cvt_pk_bf16_f32 v60, 0, v60
    v_cvt_pk_bf16_f32 v53, 0, v53
    v_cvt_pk_bf16_f32 v61, 0, v61
    v_add_f32 v49, 1.0, v49
    v_add_f32 v57, 1.0, v57
    v_mul_f32 v50, v50, v48
    v_mul_f32 v58, v58, v56
    v_mul_f32 v51, v51, v48
    v_mul_f32 v59, v59, v56
    v_mul_f32 v52, v52, v48
    v_mul_f32 v60, v60, v56
    v_mul_f32 v53, v53, v48
    v_mul_f32 v61, v61, v56
    v_cvt_pk_bf16_f32 v49, 0, v49
    v_cvt_pk_bf16_f32 v57, 0, v57
    v_cvt_pk_bf16_f32 v50, 0, v50
    v_cvt_pk_bf16_f32 v58, 0, v58
    v_cvt_pk_bf16_f32 v51, 0, v51
    v_cvt_pk_bf16_f32 v59, 0, v59
    v_cvt_pk_bf16_f32 v52, 0, v52
    v_cvt_pk_bf16_f32 v60, 0, v60
    v_cvt_pk_bf16_f32 v53, 0, v53
    v_cvt_pk_bf16_f32 v61, 0, v61
    v_mul_f32 v49, 0.5, v49
    v_mul_f32 v57, 0.5, v57
    v_cvt_pk_bf16_f32 v49, 0, v49
    v_cvt_pk_bf16_f32 v57, 0, v57
    v_mul_f32 v50, v50, v49
    v_mul_f32 v58, v58, v57
    v_mul_f32 v51, v51, v49
    v_mul_f32 v59, v59, v57
    v_mul_f32 v52, v52, v49
    v_mul_f32 v60, v60, v57
    v_mul_f32 v53, v53, v49
    v_mul_f32 v61, v61, v57
    v_cvt_pk_bf16_f32 v46, v50, v51
    v_cvt_pk_bf16_f32 v36, v58, v59
    v_cvt_pk_bf16_f32 v47, v52, v53
    v_cvt_pk_bf16_f32 v37, v60, v61
    v_cmp_gt_u32 vcc, 8192, v45
    s_nop 0
    s_mov_b64 exec, vcc
    ds_write_b64 v45, v[46:47] offset:6656
    ds_write_b64 v45, v[36:37] offset:14848
    s_mov_b64 exec, -1
    v_add_u32 v44, 0x300000, v44
    v_add_u32 v45, 1536, v45
    s_sub_u32 s94, s94, 1
    s_waitcnt lgkmcnt(0)
    v_readfirstlane_b32 s3, v39
    s_nop 0
    s_cmp_lt_u32 s3, 8
    s_cbranch_scc1 A_GT1
A_GT1_D:
    s_setprio 3
    s_cmp_lg_u32 s48, 13
    s_cbranch_scc1 A_X1
    buffer_load_dword v4, v6, s[44:47], 0 offen sc0 sc1
    s_branch A_X1b
A_X1:
    v_lshrrev_b32 v12, 2, v8
    v_and_b32 v13, 3, v8
    v_lshlrev_b32 v5, 10, v9
    v_lshl_add_u32 v5, v12, 8, v5
    v_lshl_add_u32 v5, v13, 4, v5
    s_sub_u32 s92, s48, 14
    s_lshl_b32 s93, s92, 10
    s_add_u32 s93, s93, 109312
    s_lshl_b32 s92, s92, 2
    s_add_u32 s92, s92, s96
    s_lshl_b32 s92, s92, 10
    s_lshl_b32 s3, s49, 6
    s_add_u32 s92, s92, s3
    s_add_u32 s92, s92, 256
    v_mov_b32 v11, 2360
A_LI:
    ds_read_b32 v10, v11
    s_waitcnt lgkmcnt(0)
    v_readfirstlane_b32 s3, v10
    s_nop 0
    s_cmp_ge_u32 s3, 5
    s_cbranch_scc1 A_LI_OK
    s_sleep 1
    s_branch A_LI
A_LI_OK:
    s_mov_b32 exec_lo, 0x0fff0fff
    s_mov_b32 exec_hi, 0x0fff0fff
    buffer_load_dwordx4 v[92:95], v5, s[12:15], s92 offen
    s_add_u32 s92, s92, 8192
    buffer_load_dwordx4 v[96:99], v5, s[12:15], s92 offen
    s_add_u32 s92, s92, 8192
    buffer_load_dwordx4 v[100:103], v5, s[12:15], s92 offen
    s_add_u32 s92, s92, 8192
    buffer_load_dwordx4 v[104:107], v5, s[12:15], s92 offen
    s_add_u32 s92, s92, 8192
    buffer_load_dwordx4 v[108:111], v5, s[12:15], s92 offen
    s_add_u32 s92, s92, 8192
    s_mov_b64 exec, -1
A_X1b:
    v_subrev_u32 v13, 832, v0
    v_lshlrev_b32 v13, 4, v13
    v_add_u32 v12, 88832, v13
    v_lshlrev_b32 v14, 2, v1
    s_mul_i32 s41, s2, 18816
    s_add_u32 s41, s41, 196608
    v_mov_b32 v11, 2328
A_SW:
    ds_read_b32 v10, v11
    s_waitcnt lgkmcnt(0)
    v_readfirstlane_b32 s3, v10
    s_nop 0
    s_cmp_ge_u32 s3, 8
    s_cbranch_scc1 A_SW_OK
    s_sleep 1
    s_branch A_SW
A_SW_OK:
    ds_read_b32 v15, v14 offset:2048
    ds_read_b128 v[64:67], v12 offset:0
    ds_read_b128 v[68:71], v12 offset:3072
    ds_read_b128 v[72:75], v12 offset:6144
    ds_read_b128 v[76:79], v12 offset:9216
    ds_read_b128 v[80:83], v12 offset:12288
    ds_read_b128 v[84:87], v12 offset:15360
    ds_read_b128 v[88:91], v12 offset:18432
    v_mov_b32 v126, 2332
    v_mov_b32 v127, 1
    s_mov_b64 exec, 1
    ds_add_u32 v126, v127
    s_mov_b64 exec, -1
    s_waitcnt lgkmcnt(8)
    v_mov_b32 v14, v15
    s_nop 1
    v_add_u32_dpp v14, v14, v14 row_shr:1 row_mask:0xf bank_mask:0xf bound_ctrl:0
    s_nop 1
    v_add_u32_dpp v14, v14, v14 row_shr:2 row_mask:0xf bank_mask:0xf bound_ctrl:0
    s_nop 1
    v_add_u32_dpp v14, v14, v14 row_shr:4 row_mask:0xf bank_mask:0xf bound_ctrl:0
    s_nop 1
    v_add_u32_dpp v14, v14, v14 row_shr:8 row_mask:0xf bank_mask:0xf bound_ctrl:0
    s_nop 1
    v_add_u32_dpp v14, v14, v14 row_bcast:15 row_mask:0xa bank_mask:0xf
    s_nop 1
    v_add_u32_dpp v14, v14, v14 row_bcast:31 row_mask:0xc bank_mask:0xf
    s_nop 0
    v_readlane_b32 s43, v14, 63
    v_sub_u32 v14, v14, v15
    v_lshl_or_b32 v34, v15, 16, v14
    s_mul_i32 s43, s43, 12
    s_waitcnt lgkmcnt(0)
    v_cmp_gt_i32 vcc, s43, v13
    s_nop 0
    s_mov_b64 exec, vcc
    buffer_store_dwordx4 v[64:67], v13, s[20:23], s41 offen sc0 sc1
    s_mov_b64 exec, -1
    s_sub_u32 s43, s43, 3072
    s_add_u32 s41, s41, 3072
    v_cmp_gt_i32 vcc, s43, v13
    s_nop 0
    s_mov_b64 exec, vcc
    buffer_store_dwordx4 v[68:71], v13, s[20:23], s41 offen sc0 sc1
    s_mov_b64 exec, -1
    s_sub_u32 s43, s43, 3072
    s_add_u32 s41, s41, 3072
    v_cmp_gt_i32 vcc, s43, v13
    s_nop 0
    s_mov_b64 exec, vcc
    buffer_store_dwordx4 v[72:75], v13, s[20:23], s41 offen sc0 sc1
    s_mov_b64 exec, -1
    s_sub_u32 s43, s43, 3072
    s_add_u32 s41, s41, 3072
    v_cmp_gt_i32 vcc, s43, v13
    s_nop 0
    s_mov_b64 exec, vcc
    buffer_store_dwordx4 v[76:79], v13, s[20:23], s41 offen sc0 sc1
    s_mov_b64 exec, -1
    s_sub_u32 s43, s43, 3072
    s_add_u32 s41, s41, 3072
    v_cmp_gt_i32 vcc, s43, v13
    s_nop 0
    s_mov_b64 exec, vcc
    buffer_store_dwordx4 v[80:83], v13, s[20:23], s41 offen sc0 sc1
    s_mov_b64 exec, -1
    s_sub_u32 s43, s43, 3072
    s_add_u32 s41, s41, 3072
    v_cmp_gt_i32 vcc, s43, v13
    s_nop 0
    s_mov_b64 exec, vcc
    buffer_store_dwordx4 v[84:87], v13, s[20:23], s41 offen sc0 sc1
    s_mov_b64 exec, -1
    s_sub_u32 s43, s43, 3072
    s_add_u32 s41, s41, 3072
    v_cmp_gt_i32 vcc, s43, v13
    s_nop 0
    s_mov_b64 exec, vcc
    buffer_store_dwordx4 v[88:91], v13, s[20:23], s41 offen sc0 sc1
    s_mov_b64 exec, -1
    s_sub_u32 s43, s43, 3072
    s_add_u32 s41, s41, 3072
    s_waitcnt vmcnt(0)
    v_mov_b32 v126, 2344
    v_mov_b32 v127, 1
    s_mov_b64 exec, 1
    ds_add_u32 v126, v127
    s_mov_b64 exec, -1
    s_cmp_lg_u32 s48, 13
    s_cbranch_scc1 A_X2
    s_mov_b32 s40, 131072
    v_mov_b32 v6, 0
A_N0:
    v_readfirstlane_b32 s25, v4
    s_sub_u32 s40, s40, 1
    s_cbranch_scc1 A_N0_OK
    s_cmp_lg_u32 s25, 0
    s_cbranch_scc1 A_N0_OK
    buffer_load_dword v4, v6, s[44:47], 0 offen sc0 sc1
    s_waitcnt vmcnt(0)
    s_branch A_N0
A_N0_OK:
    v_mov_b32 v35, s25
    ds_write_b32 v6, v35 offset:2372
    v_lshlrev_b32 v12, 11, v1
    s_lshl_b32 s93, s2, 3
    v_mov_b32 v11, 2344
A_DW0:
    ds_read_b32 v10, v11
    s_waitcnt lgkmcnt(0)
    v_readfirstlane_b32 s3, v10
    s_nop 0
    s_cmp_ge_u32 s3, 3
    s_cbranch_scc1 A_DW0_OK
    s_sleep 1
    s_branch A_DW0
A_DW0_OK:
    buffer_store_dwordx2 v[34:35], v12, s[20:23], s93 offen sc0 sc1
    v_mov_b32 v126, 2344
    v_mov_b32 v127, 1
    s_mov_b64 exec, 1
    ds_add_u32 v126, v127
    s_mov_b64 exec, -1
    s_branch A_X4
A_X2:
    v_add_u32 v12, s93, v7
    v_mov_b32 v11, 2336
A_SC:
    ds_read_b32 v10, v11
    s_waitcnt lgkmcnt(0)
    v_readfirstlane_b32 s3, v10
    s_nop 0
    s_cmp_ge_u32 s3, 13
    s_cbranch_scc1 A_SC_OK
    s_sleep 1
    s_branch A_SC
A_SC_OK:
    v_mov_b32 v11, 2344
A_GW:
    ds_read_b32 v10, v11
    s_waitcnt lgkmcnt(0)
    v_readfirstlane_b32 s3, v10
    s_nop 0
    s_cmp_ge_u32 s3, 4
    s_cbranch_scc1 A_GW_OK
    s_sleep 1
    s_branch A_GW
A_GW_OK:
    s_add_u32 m0, s93, 10240
    s_mov_b32 exec_lo, 0x0fff0fff
    s_mov_b32 exec_hi, 0x0fff0fff
    buffer_load_dwordx4 v5, s[12:15], s92 offen lds
    s_add_u32 s92, s92, 8192
    s_add_u32 m0, m0, 2048
    s_nop 0
    buffer_load_dwordx4 v5, s[12:15], s92 offen lds
    s_add_u32 s92, s92, 8192
    s_add_u32 m0, m0, 2048
    s_nop 0
    buffer_load_dwordx4 v5, s[12:15], s92 offen lds
    s_add_u32 s92, s92, 8192
    s_add_u32 m0, m0, 2048
    s_nop 0
    buffer_load_dwordx4 v5, s[12:15], s92 offen lds
    s_add_u32 s92, s92, 8192
    s_add_u32 m0, m0, 2048
    s_nop 0
    buffer_load_dwordx4 v5, s[12:15], s92 offen lds
    s_add_u32 s92, s92, 8192
    s_add_u32 m0, m0, 2048
    s_nop 0
    buffer_load_dwordx4 v5, s[12:15], s92 offen lds
    s_add_u32 s92, s92, 8192
    s_add_u32 m0, m0, 2048
    s_nop 0
    buffer_load_dwordx4 v5, s[12:15], s92 offen lds
    s_add_u32 s92, s92, 8192
    s_add_u32 m0, m0, 2048
    s_nop 0
    buffer_load_dwordx4 v5, s[12:15], s92 offen lds
    s_add_u32 s92, s92, 8192
    s_add_u32 m0, m0, 2048
    s_nop 0
    buffer_load_dwordx4 v5, s[12:15], s92 offen lds
    s_add_u32 s92, s92, 8192
    s_add_u32 m0, m0, 2048
    s_nop 0
    buffer_load_dwordx4 v5, s[12:15], s92 offen lds
    s_add_u32 s92, s92, 8192
    s_add_u32 m0, m0, 2048
    s_nop 0
    buffer_load_dwordx4 v5, s[12:15], s92 offen lds
    s_add_u32 s92, s92, 8192
    s_add_u32 m0, m0, 2048
    s_nop 0
    buffer_load_dwordx4 v5, s[12:15], s92 offen lds
    s_add_u32 s92, s92, 8192
    s_add_u32 m0, m0, 2048
    s_nop 0
    buffer_load_dwordx4 v5, s[12:15], s92 offen lds
    s_add_u32 s92, s92, 8192
    s_add_u32 m0, m0, 2048
    s_nop 0
    buffer_load_dwordx4 v5, s[12:15], s92 offen lds
    s_add_u32 s92, s92, 8192
    s_add_u32 m0, m0, 2048
    s_nop 0
    buffer_load_dwordx4 v5, s[12:15], s92 offen lds
    s_add_u32 s92, s92, 8192
    s_add_u32 m0, m0, 2048
    s_nop 0
    buffer_load_dwordx4 v5, s[12:15], s92 offen lds
    s_add_u32 s92, s92, 8192
    s_add_u32 m0, m0, 2048
    s_nop 0
    buffer_load_dwordx4 v5, s[12:15], s92 offen lds
    s_add_u32 s92, s92, 8192
    s_add_u32 m0, m0, 2048
    s_nop 0
    buffer_load_dwordx4 v5, s[12:15], s92 offen lds
    s_add_u32 s92, s92, 8192
    s_add_u32 m0, m0, 2048
    s_nop 0
    buffer_load_dwordx4 v5, s[12:15], s92 offen lds
    s_add_u32 s92, s92, 8192
    s_add_u32 m0, m0, 2048
    s_nop 0
    buffer_load_dwordx4 v5, s[12:15], s92 offen lds
    s_add_u32 s92, s92, 8192
    s_add_u32 m0, m0, 2048
    ds_write_b128 v12, v[92:95] offset:0
    ds_write_b128 v12, v[96:99] offset:2048
    ds_write_b128 v12, v[100:103] offset:4096
    ds_write_b128 v12, v[104:107] offset:6144
    ds_write_b128 v12, v[108:111] offset:8192
    s_mov_b64 exec, -1
    s_waitcnt vmcnt(0)
    v_mov_b32 v126, 2348
    v_mov_b32 v127, 1
    s_mov_b64 exec, 1
    ds_add_u32 v126, v127
    s_mov_b64 exec, -1
    s_waitcnt lgkmcnt(0)
    s_cmp_lg_u32 s48, 14
    s_cbranch_scc1 A_X4
    s_mov_b32 s40, s34
    s_mov_b32 s41, s35
    s_mov_b32 s42, 0x3000
    s_mov_b32 s43, 0x20000
    v_mul_u32_u24 v10, 3072, v9
    v_lshl_add_u32 v10, v8, 2, v10
    s_lshl_b32 s3, s49, 6
    buffer_load_dword v96, v10, s[40:43], s3 offen offset:256
    buffer_load_dword v100, v10, s[40:43], s3 offen offset:512
    buffer_load_dword v97, v10, s[40:43], s3 offen offset:1024
    buffer_load_dword v101, v10, s[40:43], s3 offen offset:1280
    buffer_load_dword v98, v10, s[40:43], s3 offen offset:1792
    buffer_load_dword v102, v10, s[40:43], s3 offen offset:2048
    buffer_load_dword v99, v10, s[40:43], s3 offen offset:2560
    buffer_load_dword v103, v10, s[40:43], s3 offen offset:2816
    v_and_b32 v11, 1, v9
    v_mul_u32_u24 v11, 6144, v11
    v_and_b32 v12, 7, v1
    v_lshl_add_u32 v11, v12, 4, v11
    v_lshrrev_b32 v12, 1, v9
    v_bfe_u32 v13, v1, 3, 1
    v_cmp_eq_u32 vcc, v12, v13
    v_mov_b32 v12, 0x40000000
    s_nop 0
    v_cndmask_b32 v11, v12, v11, vcc
    s_add_u32 s3, s24, 3072
    buffer_load_dwordx4 v[64:67], v11, s[40:43], s24 offen offset:0
    buffer_load_dwordx4 v[68:71], v11, s[40:43], s24 offen offset:768
    buffer_load_dwordx4 v[72:75], v11, s[40:43], s24 offen offset:1536
    buffer_load_dwordx4 v[76:79], v11, s[40:43], s24 offen offset:2304
    buffer_load_dwordx4 v[80:83], v11, s[40:43], s3 offen offset:0
    buffer_load_dwordx4 v[84:87], v11, s[40:43], s3 offen offset:768
    buffer_load_dwordx4 v[88:91], v11, s[40:43], s3 offen offset:1536
    buffer_load_dwordx4 v[92:95], v11, s[40:43], s3 offen offset:2304
A_X4:
    s_setprio 3
    s_cmp_eq_u32 s48, 13
    s_cbranch_scc1 A_X13
    s_cmp_eq_u32 s48, 15
    s_cbranch_scc1 A_X15
    v_add_u32 v12, 99072, v7
    s_waitcnt vmcnt(0)
    v_perm_b32 v104, v97, v96, s90
    v_perm_b32 v105, v99, v98, s90
    v_perm_b32 v106, v97, v96, s91
    v_perm_b32 v107, v99, v98, s91
    ds_write_b128 v12, v[104:107] offset:0
    v_perm_b32 v108, v101, v100, s90
    v_perm_b32 v109, v103, v102, s90
    v_perm_b32 v110, v101, v100, s91
    v_perm_b32 v111, v103, v102, s91
    ds_write_b128 v12, v[108:111] offset:1024
    v_perm_b32 v112, v68, v64, s90
    v_perm_b32 v113, v76, v72, s90
    v_perm_b32 v114, v84, v80, s90
    v_perm_b32 v115, v92, v88, s90
    ds_write_b128 v12, v[112:115] offset:2048
    v_perm_b32 v116, v68, v64, s91
    v_perm_b32 v117, v76, v72, s91
    v_perm_b32 v118, v84, v80, s91
    v_perm_b32 v119, v92, v88, s91
    ds_write_b128 v12, v[116:119] offset:3072
    v_perm_b32 v120, v69, v65, s90
    v_perm_b32 v121, v77, v73, s90
    v_perm_b32 v122, v85, v81, s90
    v_perm_b32 v123, v93, v89, s90
    ds_write_b128 v12, v[120:123] offset:4096
    v_perm_b32 v112, v69, v65, s91
    v_perm_b32 v113, v77, v73, s91
    v_perm_b32 v114, v85, v81, s91
    v_perm_b32 v115, v93, v89, s91
    ds_write_b128 v12, v[112:115] offset:5120
    v_perm_b32 v116, v70, v66, s90
    v_perm_b32 v117, v78, v74, s90
    v_perm_b32 v118, v86, v82, s90
    v_perm_b32 v119, v94, v90, s90
    ds_write_b128 v12, v[116:119] offset:6144
    v_perm_b32 v120, v70, v66, s91
    v_perm_b32 v121, v78, v74, s91
    v_perm_b32 v122, v86, v82, s91
    v_perm_b32 v123, v94, v90, s91
    ds_write_b128 v12, v[120:123] offset:7168
    v_perm_b32 v112, v71, v67, s90
    v_perm_b32 v113, v79, v75, s90
    v_perm_b32 v114, v87, v83, s90
    v_perm_b32 v115, v95, v91, s90
    ds_write_b128 v12, v[112:115] offset:8192
    v_perm_b32 v116, v71, v67, s91
    v_perm_b32 v117, v79, v75, s91
    v_perm_b32 v118, v87, v83, s91
    v_perm_b32 v119, v95, v91, s91
    ds_write_b128 v12, v[116:119] offset:9216
A_X15:
    s_branch A_AUG
A_X13:
    v_mov_b32 v11, 2368
A_PD:
    ds_read_b32 v10, v11
    s_waitcnt lgkmcnt(0)
    v_readfirstlane_b32 s3, v10
    s_nop 0
    s_cmp_ge_u32 s3, 2
    s_cbranch_scc1 A_PD_OK
    s_sleep 2
    s_branch A_PD
A_PD_OK:
    s_lshl_b32 s44, s50, 11
    v_lshlrev_b32 v10, 5, v1
    s_mov_b32 s45, 131072
A_GL:
    buffer_load_dwordx4 v[64:67], v10, s[20:23], s44 offen sc0 sc1
    buffer_load_dwordx4 v[68:71], v10, s[20:23], s44 offen offset:16 sc0 sc1
    s_waitcnt vmcnt(0)
    v_xor_b32 v65, v65, v35
    v_xor_b32 v67, v67, v35
    v_xor_b32 v69, v69, v35
    v_xor_b32 v71, v71, v35
    v_or3_b32 v11, v65, v67, v69
    v_or_b32 v11, v11, v71
    v_cmp_ne_u32 vcc, 0, v11
    s_cbranch_vccz A_GOK
    s_sub_u32 s45, s45, 1
    s_cbranch_scc1 A_GBAD
    s_sleep 4
    s_branch A_GL
A_GBAD:
    v_mov_b32 v64, 0
    v_mov_b32 v66, 0
    v_mov_b32 v68, 0
    v_mov_b32 v70, 0
A_GOK:
    v_mov_b32 v65, v66
    v_mov_b32 v66, v68
    v_mov_b32 v67, v70
    ds_write_b128 v7, v[64:67] offset:3072
    v_max3_u32 v11, v64, v65, v66
    v_max_u32 v11, v11, v67
    v_lshrrev_b32 v11, 16, v11
    v_add_u32 v11, 1, v11
    v_mov_b32 v10, 2312
    ds_max_u32 v10, v11
A_AUG:
    s_setprio 1
A_GT2:
    s_cmp_eq_u32 s94, 0
    s_cbranch_scc1 A_GT2_D
    v_add_u32 v38, 0x1000000, v44
    v_rcp_f32 v48, v44
    v_rcp_f32 v56, v38
    v_mul_f32 v49, 0x40490fdb, v44
    v_mul_f32 v57, 0x40490fdb, v38
    v_mul_f32 v50, v40, v44
    v_mul_f32 v58, v40, v38
    v_mul_f32 v51, v41, v44
    v_mul_f32 v59, v41, v38
    v_mul_f32 v52, v42, v44
    v_mul_f32 v60, v42, v38
    v_mul_f32 v53, v43, v44
    v_mul_f32 v61, v43, v38
    v_cvt_pk_bf16_f32 v49, 0, v49
    v_cvt_pk_bf16_f32 v57, 0, v57
    v_cvt_pk_bf16_f32 v50, 0, v50
    v_cvt_pk_bf16_f32 v58, 0, v58
    v_cvt_pk_bf16_f32 v51, 0, v51
    v_cvt_pk_bf16_f32 v59, 0, v59
    v_cvt_pk_bf16_f32 v52, 0, v52
    v_cvt_pk_bf16_f32 v60, 0, v60
    v_cvt_pk_bf16_f32 v53, 0, v53
    v_cvt_pk_bf16_f32 v61, 0, v61
    v_mul_f32 v49, 0x3e4ccccd, v49
    v_mul_f32 v57, 0x3e4ccccd, v57
    v_mul_f32 v50, 0.15915494, v50
    v_mul_f32 v58, 0.15915494, v58
    v_mul_f32 v51, 0.15915494, v51
    v_mul_f32 v59, 0.15915494, v59
    v_mul_f32 v52, 0.15915494, v52
    v_mul_f32 v60, 0.15915494, v60
    v_mul_f32 v53, 0.15915494, v53
    v_mul_f32 v61, 0.15915494, v61
    v_cvt_pk_bf16_f32 v49, 0, v49
    v_cvt_pk_bf16_f32 v57, 0, v57
    v_rndne_f32 v54, v50
    v_rndne_f32 v62, v58
    v_sub_f32 v50, v50, v54
    v_sub_f32 v58, v58, v62
    v_rndne_f32 v54, v51
    v_rndne_f32 v62, v59
    v_sub_f32 v51, v51, v54
    v_sub_f32 v59, v59, v62
    v_rndne_f32 v54, v52
    v_rndne_f32 v62, v60
    v_sub_f32 v52, v52, v54
    v_sub_f32 v60, v60, v62
    v_rndne_f32 v54, v53
    v_rndne_f32 v62, v61
    v_sub_f32 v53, v53, v54
    v_sub_f32 v61, v61, v62
    v_mul_f32 v49, 0.15915494, v49
    v_mul_f32 v57, 0.15915494, v57
    v_cos_f32 v49, v49
    v_cos_f32 v57, v57
    v_sin_f32 v50, v50
    v_sin_f32 v58, v58
    v_sin_f32 v51, v51
    v_sin_f32 v59, v59
    v_sin_f32 v52, v52
    v_sin_f32 v60, v60
    v_sin_f32 v53, v53
    v_sin_f32 v61, v61
    v_cvt_pk_bf16_f32 v49, 0, v49
    v_cvt_pk_bf16_f32 v57, 0, v57
    v_cvt_pk_bf16_f32 v50, 0, v50
    v_cvt_pk_bf16_f32 v58, 0, v58
    v_cvt_pk_bf16_f32 v51, 0, v51
    v_cvt_pk_bf16_f32 v59, 0, v59
    v_cvt_pk_bf16_f32 v52, 0, v52
    v_cvt_pk_bf16_f32 v60, 0, v60
    v_cvt_pk_bf16_f32 v53, 0, v53
    v_cvt_pk_bf16_f32 v61, 0, v61
    v_add_f32 v49, 1.0, v49
    v_add_f32 v57, 1.0, v57
    v_mul_f32 v50, v50, v48
    v_mul_f32 v58, v58, v56
    v_mul_f32 v51, v51, v48
    v_mul_f32 v59, v59, v56
    v_mul_f32 v52, v52, v48
    v_mul_f32 v60, v60, v56
    v_mul_f32 v53, v53, v48
    v_mul_f32 v61, v61, v56
    v_cvt_pk_bf16_f32 v49, 0, v49
    v_cvt_pk_bf16_f32 v57, 0, v57
    v_cvt_pk_bf16_f32 v50, 0, v50
    v_cvt_pk_bf16_f32 v58, 0, v58
    v_cvt_pk_bf16_f32 v51, 0, v51
    v_cvt_pk_bf16_f32 v59, 0, v59
    v_cvt_pk_bf16_f32 v52, 0, v52
    v_cvt_pk_bf16_f32 v60, 0, v60
    v_cvt_pk_bf16_f32 v53, 0, v53
    v_cvt_pk_bf16_f32 v61, 0, v61
    v_mul_f32 v49, 0.5, v49
    v_mul_f32 v57, 0.5, v57
    v_cvt_pk_bf16_f32 v49, 0, v49
    v_cvt_pk_bf16_f32 v57, 0, v57
    v_mul_f32 v50, v50, v49
    v_mul_f32 v58, v58, v57
    v_mul_f32 v51, v51, v49
    v_mul_f32 v59, v59, v57
    v_mul_f32 v52, v52, v49
    v_mul_f32 v60, v60, v57
    v_mul_f32 v53, v53, v49
    v_mul_f32 v61, v61, v57
    v_cvt_pk_bf16_f32 v46, v50, v51
    v_cvt_pk_bf16_f32 v36, v58, v59
    v_cvt_pk_bf16_f32 v47, v52, v53
    v_cvt_pk_bf16_f32 v37, v60, v61
    v_cmp_gt_u32 vcc, 8192, v45
    s_nop 0
    s_mov_b64 exec, vcc
    ds_write_b64 v45, v[46:47] offset:6656
    ds_write_b64 v45, v[36:37] offset:14848
    s_mov_b64 exec, -1
    v_add_u32 v44, 0x300000, v44
    v_add_u32 v45, 1536, v45
    s_sub_u32 s94, s94, 1
    s_branch A_GT2
A_GT2_D:
    s_setprio 3
A_AUX:
    s_mov_b32 s27, 0
    s_sub_u32 s26, s48, 5
    v_mov_b32 v11, 2312
A_RWX:
    ds_read_b32 v10, v11
    s_waitcnt lgkmcnt(0)
    v_readfirstlane_b32 s3, v10
    s_nop 0
    s_cmp_ge_u32 s3, 1
    s_cbranch_scc1 A_RWX_OK
    s_sleep 2
    s_branch A_RWX
A_RWX_OK:
    s_mov_b32 s95, 0
    v_mov_b32 v62, 0
    v_mov_b32 v63, 0
    v_mov_b32 v35, 0
    s_cmp_ge_u32 s26, 11
    s_cbranch_scc1 RL1
    s_lshl_b32 s3, s26, 3
    v_lshrrev_b32 v5, 3, v1
    v_add_u32 v5, s3, v5
    v_lshlrev_b32 v6, 2, v5
    ds_read_b32 v32, v6 offset:3072
    ds_read_b32 v33, v6 offset:3424
    ds_read_b32 v34, v6 offset:3776
    v_mul_u32_u24 v5, 18816, v5
    v_and_b32 v6, 7, v1
    v_add_u32 v7, s51, v6
    v_mad_u32_u24 v5, v7, 12, v5
    s_cmp_eq_u32 s26, 10
    s_cselect_b32 s3, 0, -1
    s_waitcnt lgkmcnt(0)
    v_and_b32 v34, s3, v34
    v_and_b32 v7, 0xffff, v32
    v_mad_u32_u24 v62, v7, 12, v5
    v_lshrrev_b32 v32, 16, v32
    v_subrev_u32 v32, s51, v32
    v_min_i32 v32, s52, v32
    v_sub_u32 v32, v32, v6
    v_and_b32 v7, 0xffff, v33
    v_mad_u32_u24 v63, v7, 12, v5
    v_lshrrev_b32 v33, 16, v33
    v_subrev_u32 v33, s51, v33
    v_min_i32 v33, s52, v33
    v_sub_u32 v33, v33, v6
    v_and_b32 v7, 0xffff, v34
    v_mad_u32_u24 v35, v7, 12, v5
    v_lshrrev_b32 v34, 16, v34
    v_subrev_u32 v34, s51, v34
    v_min_i32 v34, s52, v34
    v_sub_u32 v34, v34, v6
    v_cmp_lt_i32 s[64:65], 0, v32
    v_cmp_lt_i32 s[66:67], 0, v33
    v_cmp_lt_i32 s[68:69], 0, v34
    v_cmp_lt_i32 s[70:71], 8, v32
    v_cmp_lt_i32 s[72:73], 8, v33
    v_cmp_lt_i32 s[74:75], 8, v34
    v_cmp_lt_i32 s[76:77], 16, v32
    v_cmp_lt_i32 s[78:79], 16, v33
    v_cmp_lt_i32 s[80:81], 16, v34
    v_cmp_lt_i32 s[82:83], 24, v32
    v_cmp_lt_i32 s[84:85], 24, v33
    v_cmp_lt_i32 s[86:87], 24, v34
    v_max3_i32 v7, v32, v33, v34
    s_mov_b32 s95, 6
    v_cmp_lt_i32 vcc, 16, v7
    s_nop 0
    s_cmp_lg_u64 vcc, 0
    s_cselect_b32 s95, 9, s95
    v_cmp_lt_i32 vcc, 24, v7
    s_nop 0
    s_cmp_lg_u64 vcc, 0
    s_cselect_b32 s95, 12, s95
    v_cmp_lt_i32 vcc, 32, v7
    s_nop 0
    s_cmp_lg_u64 vcc, 0
    s_cselect_b32 s95, 15, s95
    v_cmp_lt_i32 vcc, 40, v7
    s_nop 0
    s_cmp_lg_u64 vcc, 0
    s_cselect_b32 s95, 18, s95
    s_cmp_le_u32 s95, 0
    s_cbranch_scc1 FS2
    s_mov_b32 s3, 196608
    s_mov_b64 exec, s[64:65]
    buffer_load_dwordx3 v[64:66], v62, s[20:23], s3 offen offset:0 sc1
    s_mov_b32 s3, 1852416
    s_mov_b64 exec, s[66:67]
    buffer_load_dwordx3 v[68:70], v63, s[20:23], s3 offen offset:0 sc1
    s_mov_b32 s3, 3508224
    s_mov_b64 exec, s[68:69]
    buffer_load_dwordx3 v[72:74], v35, s[20:23], s3 offen offset:0 sc1
    s_mov_b32 s3, 196608
    s_mov_b64 exec, s[70:71]
    buffer_load_dwordx3 v[76:78], v62, s[20:23], s3 offen offset:96 sc1
    s_mov_b32 s3, 1852416
    s_mov_b64 exec, s[72:73]
    buffer_load_dwordx3 v[80:82], v63, s[20:23], s3 offen offset:96 sc1
    s_mov_b32 s3, 3508224
    s_mov_b64 exec, s[74:75]
    buffer_load_dwordx3 v[84:86], v35, s[20:23], s3 offen offset:96 sc1
    s_cmp_le_u32 s95, 6
    s_cbranch_scc1 FS2
    s_mov_b32 s3, 196608
    s_mov_b64 exec, s[76:77]
    buffer_load_dwordx3 v[88:90], v62, s[20:23], s3 offen offset:192 sc1
    s_mov_b32 s3, 1852416
    s_mov_b64 exec, s[78:79]
    buffer_load_dwordx3 v[92:94], v63, s[20:23], s3 offen offset:192 sc1
    s_mov_b32 s3, 3508224
    s_mov_b64 exec, s[80:81]
    buffer_load_dwordx3 v[96:98], v35, s[20:23], s3 offen offset:192 sc1
    s_cmp_le_u32 s95, 9
    s_cbranch_scc1 FS2
    s_mov_b32 s3, 196608
    s_mov_b64 exec, s[82:83]
    buffer_load_dwordx3 v[100:102], v62, s[20:23], s3 offen offset:288 sc1
    s_mov_b32 s3, 1852416
    s_mov_b64 exec, s[84:85]
    buffer_load_dwordx3 v[104:106], v63, s[20:23], s3 offen offset:288 sc1
    s_mov_b32 s3, 3508224
    s_mov_b64 exec, s[86:87]
    buffer_load_dwordx3 v[108:110], v35, s[20:23], s3 offen offset:288 sc1
FS2:
    s_mov_b64 exec, -1
RL1:
    v_mov_b32 v126, 2376
    v_mov_b32 v127, 1
    s_mov_b64 exec, 1
    ds_add_u32 v126, v127
    s_mov_b64 exec, -1
    s_branch A_W0
A_E:
    s_setprio 3
    s_mov_b32 s36, s68
    s_mov_b32 s37, s69
    s_mov_b32 s38, 0x186a00
    s_mov_b32 s39, 0x20000
    s_mov_b32 s40, s70
    s_mov_b32 s41, s71
    s_mov_b32 s42, 0x186a00
    s_mov_b32 s43, 0x20000
    s_mov_b32 s88, s66
    s_mov_b32 s89, s67
    s_mov_b32 s90, 0x124f8
    s_mov_b32 s91, 0x20000
    s_mul_i32 s3, s2, 6252
    s_add_u32 s93, s3, 4096
    buffer_load_dword v16, v5, s[36:39], s3 offen offset:0
    buffer_load_dword v24, v5, s[40:43], s3 offen offset:0
    buffer_load_dword v17, v5, s[36:39], s3 offen offset:2048
    buffer_load_dword v25, v5, s[40:43], s3 offen offset:2048
    buffer_load_dword v18, v5, s[36:39], s93 offen offset:0
    buffer_load_dword v26, v5, s[40:43], s93 offen offset:0
    buffer_load_dword v19, v5, s[36:39], s93 offen offset:2048
    buffer_load_dword v27, v5, s[40:43], s93 offen offset:2048
    s_mul_i32 s93, s94, 7
    s_add_u32 s93, s93, s48
    s_mul_i32 s3, s93, 886
    s_lshr_b32 s3, s3, 16
    s_mul_i32 s3, s3, 74
    s_sub_u32 s3, s93, s3
    s_lshl_b32 s3, s3, 10
    s_add_u32 m0, s3, 88832
    s_nop 0
    buffer_load_dwordx4 v7, s[88:91], s3 offen lds
    s_add_u32 s93, s93, 8
    s_mul_i32 s3, s93, 886
    s_lshr_b32 s3, s3, 16
    s_mul_i32 s3, s3, 74
    s_sub_u32 s3, s93, s3
    s_lshl_b32 s3, s3, 10
    s_add_u32 m0, s3, 88832
    s_nop 0
    buffer_load_dwordx4 v7, s[88:91], s3 offen lds
    s_add_u32 s93, s93, 8
    s_mul_i32 s3, s93, 886
    s_lshr_b32 s3, s3, 16
    s_mul_i32 s3, s3, 74
    s_sub_u32 s3, s93, s3
    s_lshl_b32 s3, s3, 10
    s_add_u32 m0, s3, 88832
    s_nop 0
    buffer_load_dwordx4 v7, s[88:91], s3 offen lds
    s_add_u32 s93, s93, 8
    s_mul_i32 s3, s93, 886
    s_lshr_b32 s3, s3, 16
    s_mul_i32 s3, s3, 74
    s_sub_u32 s3, s93, s3
    s_lshl_b32 s3, s3, 10
    s_add_u32 m0, s3, 88832
    s_nop 0
    buffer_load_dwordx4 v7, s[88:91], s3 offen lds
    s_add_u32 s93, s93, 8
    s_mul_i32 s3, s93, 886
    s_lshr_b32 s3, s3, 16
    s_mul_i32 s3, s3, 74
    s_sub_u32 s3, s93, s3
    s_lshl_b32 s3, s3, 10
    s_add_u32 m0, s3, 88832
    s_nop 0
    buffer_load_dwordx4 v7, s[88:91], s3 offen lds
    s_add_u32 s93, s93, 8
    s_mul_i32 s3, s93, 886
    s_lshr_b32 s3, s3, 16
    s_mul_i32 s3, s3, 74
    s_sub_u32 s3, s93, s3
    s_lshl_b32 s3, s3, 10
    s_add_u32 m0, s3, 88832
    s_nop 0
    buffer_load_dwordx4 v7, s[88:91], s3 offen lds
    s_add_u32 s93, s93, 8
    s_mul_i32 s3, s93, 886
    s_lshr_b32 s3, s3, 16
    s_mul_i32 s3, s3, 74
    s_sub_u32 s3, s93, s3
    s_lshl_b32 s3, s3, 10
    s_add_u32 m0, s3, 88832
    s_nop 0
    buffer_load_dwordx4 v7, s[88:91], s3 offen lds
    s_add_u32 s93, s93, 8
    s_mul_i32 s3, s93, 886
    s_lshr_b32 s3, s3, 16
    s_mul_i32 s3, s3, 74
    s_sub_u32 s3, s93, s3
    s_lshl_b32 s3, s3, 10
    s_add_u32 m0, s3, 88832
    s_nop 0
    buffer_load_dwordx4 v7, s[88:91], s3 offen lds
    s_add_u32 s93, s93, 8
    s_mul_i32 s3, s93, 886
    s_lshr_b32 s3, s3, 16
    s_mul_i32 s3, s3, 74
    s_sub_u32 s3, s93, s3
    s_lshl_b32 s3, s3, 10
    s_add_u32 m0, s3, 88832
    s_nop 0
    buffer_load_dwordx4 v7, s[88:91], s3 offen lds
    s_add_u32 s93, s93, 8
    s_mul_i32 s3, s93, 886
    s_lshr_b32 s3, s3, 16
    s_mul_i32 s3, s3, 74
    s_sub_u32 s3, s93, s3
    s_lshl_b32 s3, s3, 10
    s_add_u32 m0, s3, 88832
    s_nop 0
    buffer_load_dwordx4 v7, s[88:91], s3 offen lds
    s_add_u32 s93, s93, 8
    s_mov_b32 s16, s80
    s_mov_b32 s17, s81
    s_mov_b32 s18, 0xc35000
    s_mov_b32 s19, 0x20000
    s_add_u32 s28, s32, 0x1418000
    s_addc_u32 s29, s33, 0
    s_mov_b32 s30, 0x1880000
    s_mov_b32 s31, 0x20000
    s_mul_i32 s3, s49, 3211264
    s_add_u32 s4, s32, s3
    s_addc_u32 s5, s33, 0
    s_mov_b32 s6, 0x30d400
    s_mov_b32 s7, 0x20000
    s_lshr_b32 s3, s49, 1
    s_lshl_b32 s24, s3, 7
    s_mul_i32 s3, s3, 1605632
    s_add_u32 s3, s3, 12845056
    s_add_u32 s8, s32, s3
    s_addc_u32 s9, s33, 0
    s_mov_b32 s10, 0x186a00
    s_mov_b32 s11, 0x20000
    s_mov_b32 s51, 0
    s_mov_b32 s52, 48
    s_mov_b32 s54, 1
    s_mov_b64 s[34:35], s[78:79]
    s_mov_b32 s90, 0x05040100
    s_mov_b32 s91, 0x07060302
    s_mul_i32 s3, s2, 1563
    s_sub_u32 s3, 400000, s3
    s_min_u32 s40, s3, 1563
    s_mov_b32 s41, 0xffffff3c
    s_mov_b32 s42, 0x2c000000
    s_mov_b32 s43, 0x47400000
    v_mov_b32 v14, 0x322bcc77
    v_mov_b32 v15, 1
    v_mov_b32 v13, 2048
    s_mov_b64 s[70:71], 0
    s_waitcnt vmcnt(10)
    v_mul_u32_u24 v32, 6, v16
    v_and_b32 v32, -4, v32
    v_add_u32 v32, 88832, v32
    v_mul_u32_u24 v33, 6, v24
    v_and_b32 v33, -4, v33
    v_add_u32 v33, 88832, v33
    v_lshlrev_b32 v116, 4, v16
    v_lshlrev_b32 v120, 4, v24
    v_mul_u32_u24 v48, 5350, v24
    v_lshrrev_b32 v48, 20, v48
    v_mad_i32_i24 v24, v48, s41, v24
    v_lshlrev_b32 v48, 2, v48
    v_add_u32 v52, v48, v13
    v_mul_u32_u24 v34, 6, v17
    v_and_b32 v34, -4, v34
    v_add_u32 v34, 88832, v34
    v_mul_u32_u24 v35, 6, v25
    v_and_b32 v35, -4, v35
    v_add_u32 v35, 88832, v35
    v_lshlrev_b32 v117, 4, v17
    v_lshlrev_b32 v121, 4, v25
    v_mul_u32_u24 v49, 5350, v25
    v_lshrrev_b32 v49, 20, v49
    v_mad_i32_i24 v25, v49, s41, v25
    v_lshlrev_b32 v49, 2, v49
    v_add_u32 v53, v49, v13
    v_mul_u32_u24 v36, 6, v18
    v_and_b32 v36, -4, v36
    v_add_u32 v36, 88832, v36
    v_mul_u32_u24 v37, 6, v26
    v_and_b32 v37, -4, v37
    v_add_u32 v37, 88832, v37
    v_lshlrev_b32 v118, 4, v18
    v_lshlrev_b32 v122, 4, v26
    v_mul_u32_u24 v50, 5350, v26
    v_lshrrev_b32 v50, 20, v50
    v_mad_i32_i24 v26, v50, s41, v26
    v_lshlrev_b32 v50, 2, v50
    v_add_u32 v54, v50, v13
    v_mul_u32_u24 v38, 6, v19
    v_and_b32 v38, -4, v38
    v_add_u32 v38, 88832, v38
    v_mul_u32_u24 v39, 6, v27
    v_and_b32 v39, -4, v39
    v_add_u32 v39, 88832, v39
    v_lshlrev_b32 v119, 4, v19
    v_lshlrev_b32 v123, 4, v27
    v_mul_u32_u24 v51, 5350, v27
    v_lshrrev_b32 v51, 20, v51
    v_mad_i32_i24 v27, v51, s41, v27
    v_lshlrev_b32 v51, 2, v51
    v_add_u32 v55, v51, v13
    s_waitcnt vmcnt(0)
    v_mov_b32 v126, 2320
    v_mov_b32 v127, 1
    s_mov_b64 exec, 1
    ds_add_u32 v126, v127
    s_mov_b64 exec, -1
    v_mov_b32 v11, 2320
A_PW0:
    ds_read_b32 v10, v11
    s_waitcnt lgkmcnt(0)
    v_readfirstlane_b32 s3, v10
    s_nop 0
    s_cmp_ge_u32 s3, 8
    s_cbranch_scc1 A_PW0_OK
    s_sleep 1
    s_branch A_PW0
A_PW0_OK:
    ds_read2_b32 v[64:65], v32 offset0:0 offset1:1
    ds_read2_b32 v[66:67], v33 offset0:0 offset1:1
    ds_read2_b32 v[68:69], v34 offset0:0 offset1:1
    ds_read2_b32 v[70:71], v35 offset0:0 offset1:1
    ds_read2_b32 v[72:73], v36 offset0:0 offset1:1
    ds_read2_b32 v[74:75], v37 offset0:0 offset1:1
    ds_read2_b32 v[76:77], v38 offset0:0 offset1:1
    ds_read2_b32 v[78:79], v39 offset0:0 offset1:1
    s_waitcnt lgkmcnt(0)
    v_alignbit_b32 v64, v65, v64, v116
    v_alignbit_b32 v68, v69, v68, v117
    v_alignbit_b32 v72, v73, v72, v118
    v_lshrrev_b32 v65, v116, v65
    v_lshrrev_b32 v69, v117, v69
    v_lshrrev_b32 v73, v118, v73
    v_alignbit_b32 v66, v67, v66, v120
    v_alignbit_b32 v70, v71, v70, v121
    v_alignbit_b32 v74, v75, v74, v122
    v_lshrrev_b32 v67, v120, v67
    v_lshrrev_b32 v71, v121, v71
    v_lshrrev_b32 v75, v122, v75
    v_lshlrev_b32 v92, 16, v64
    v_lshlrev_b32 v93, 16, v68
    v_lshlrev_b32 v94, 16, v72
    v_and_b32 v96, 0xffff0000, v64
    v_and_b32 v97, 0xffff0000, v68
    v_and_b32 v98, 0xffff0000, v72
    v_lshlrev_b32 v100, 16, v65
    v_lshlrev_b32 v101, 16, v69
    v_lshlrev_b32 v102, 16, v73
    v_lshlrev_b32 v104, 16, v66
    v_lshlrev_b32 v105, 16, v70
    v_lshlrev_b32 v106, 16, v74
    v_and_b32 v108, 0xffff0000, v66
    v_and_b32 v109, 0xffff0000, v70
    v_and_b32 v110, 0xffff0000, v74
    v_lshlrev_b32 v112, 16, v67
    v_lshlrev_b32 v113, 16, v71
    v_lshlrev_b32 v114, 16, v75
    v_sub_f32 v92, v92, v104
    v_sub_f32 v93, v93, v105
    v_sub_f32 v94, v94, v106
    v_sub_f32 v96, v96, v108
    v_sub_f32 v97, v97, v109
    v_sub_f32 v98, v98, v110
    v_sub_f32 v100, v100, v112
    v_sub_f32 v101, v101, v113
    v_sub_f32 v102, v102, v114
    v_cvt_pk_bf16_f32 v92, 0, v92
    v_cvt_pk_bf16_f32 v93, 0, v93
    v_cvt_pk_bf16_f32 v94, 0, v94
    v_cvt_pk_bf16_f32 v96, 0, v96
    v_cvt_pk_bf16_f32 v97, 0, v97
    v_cvt_pk_bf16_f32 v98, 0, v98
    v_cvt_pk_bf16_f32 v100, 0, v100
    v_cvt_pk_bf16_f32 v101, 0, v101
    v_cvt_pk_bf16_f32 v102, 0, v102
    v_mul_f32 v104, v92, v92
    v_mul_f32 v105, v93, v93
    v_mul_f32 v106, v94, v94
    v_mul_f32 v108, v96, v96
    v_mul_f32 v109, v97, v97
    v_mul_f32 v110, v98, v98
    v_mul_f32 v112, v100, v100
    v_mul_f32 v113, v101, v101
    v_mul_f32 v114, v102, v102
    v_cvt_pk_bf16_f32 v104, 0, v104
    v_cvt_pk_bf16_f32 v105, 0, v105
    v_cvt_pk_bf16_f32 v106, 0, v106
    v_cvt_pk_bf16_f32 v108, 0, v108
    v_cvt_pk_bf16_f32 v109, 0, v109
    v_cvt_pk_bf16_f32 v110, 0, v110
    v_cvt_pk_bf16_f32 v112, 0, v112
    v_cvt_pk_bf16_f32 v113, 0, v113
    v_cvt_pk_bf16_f32 v114, 0, v114
    v_add_f32 v104, v104, v108
    v_add_f32 v105, v105, v109
    v_add_f32 v106, v106, v110
    v_add_f32 v104, v104, v112
    v_add_f32 v105, v105, v113
    v_add_f32 v106, v106, v114
    v_cvt_pk_bf16_f32 v104, 0, v104
    v_cvt_pk_bf16_f32 v105, 0, v105
    v_cvt_pk_bf16_f32 v106, 0, v106
    v_add_f32 v104, v14, v104
    v_add_f32 v105, v14, v105
    v_add_f32 v106, v14, v106
    v_cvt_pk_bf16_f32 v104, 0, v104
    v_cvt_pk_bf16_f32 v105, 0, v105
    v_cvt_pk_bf16_f32 v106, 0, v106
    v_sqrt_f32 v104, v104
    v_sqrt_f32 v105, v105
    v_sqrt_f32 v106, v106
    v_lshl_or_b32 v66, v16, 8, v24
    v_lshl_or_b32 v70, v17, 8, v25
    v_lshl_or_b32 v74, v18, 8, v26
    v_cvt_pk_bf16_f32 v104, 0, v104
    v_cvt_pk_bf16_f32 v105, 0, v105
    v_cvt_pk_bf16_f32 v106, 0, v106
    v_rcp_f32 v108, v104
    v_rcp_f32 v109, v105
    v_rcp_f32 v110, v106
    v_cmp_gt_f32 vcc, 0x40a00000, v104
    s_nop 0
    s_mov_b64 s[64:65], vcc
    s_mov_b64 exec, vcc
    ds_add_rtn_u32 v56, v52, v15
    s_mov_b64 exec, -1
    v_cmp_gt_f32 vcc, 0x40a00000, v105
    s_nop 0
    s_mov_b64 s[66:67], vcc
    s_mov_b64 exec, vcc
    ds_add_rtn_u32 v57, v53, v15
    s_mov_b64 exec, -1
    v_cmp_gt_f32 vcc, 0x40a00000, v106
    s_sub_i32 s3, s40, 1024
    v_cmp_gt_i32 s[68:69], s3, v0
    s_nop 0
    s_and_b64 vcc, vcc, s[68:69]
    s_mov_b64 s[68:69], vcc
    s_mov_b64 exec, vcc
    ds_add_rtn_u32 v58, v54, v15
    s_mov_b64 exec, -1
    v_lshl_add_u32 v112, v104, 5, s42
    v_lshl_add_u32 v113, v105, 5, s42
    v_lshl_add_u32 v114, v106, 5, s42
    v_mul_f32 v92, v92, v108
    v_mul_f32 v93, v93, v109
    v_mul_f32 v94, v94, v110
    v_mul_f32 v96, v96, v108
    v_mul_f32 v97, v97, v109
    v_mul_f32 v98, v98, v110
    v_mul_f32 v100, v100, v108
    v_mul_f32 v101, v101, v109
    v_mul_f32 v102, v102, v110
    v_add_u32 v108, s43, v104
    v_add_u32 v109, s43, v105
    v_add_u32 v110, s43, v106
    v_subrev_u32 v116, 0x3ea00000, v104
    v_subrev_u32 v117, 0x3ea00000, v105
    v_subrev_u32 v118, 0x3ea00000, v106
    v_ashrrev_i32 v116, 31, v116
    v_ashrrev_i32 v117, 31, v117
    v_ashrrev_i32 v118, 31, v118
    v_bfi_b32 v112, v116, v108, v112
    v_bfi_b32 v113, v117, v109, v113
    v_bfi_b32 v114, v118, v110, v114
    v_cvt_pk_bf16_f32 v64, v92, v96
    v_cvt_pk_bf16_f32 v68, v93, v97
    v_cvt_pk_bf16_f32 v72, v94, v98
    v_cvt_pk_bf16_f32 v100, v100, 0
    v_cvt_pk_bf16_f32 v101, v101, 0
    v_cvt_pk_bf16_f32 v102, v102, 0
    v_or_b32 v65, v112, v100
    v_or_b32 v69, v113, v101
    v_or_b32 v73, v114, v102
    s_cmp_lg_u32 s48, 0
    s_cbranch_scc1 A_E4
    v_alignbit_b32 v76, v77, v76, v119
    v_lshrrev_b32 v77, v119, v77
    v_alignbit_b32 v78, v79, v78, v123
    v_lshrrev_b32 v79, v123, v79
    v_lshlrev_b32 v95, 16, v76
    v_and_b32 v99, 0xffff0000, v76
    v_lshlrev_b32 v103, 16, v77
    v_lshlrev_b32 v107, 16, v78
    v_and_b32 v111, 0xffff0000, v78
    v_lshlrev_b32 v115, 16, v79
    v_sub_f32 v95, v95, v107
    v_sub_f32 v99, v99, v111
    v_sub_f32 v103, v103, v115
    v_cvt_pk_bf16_f32 v95, 0, v95
    v_cvt_pk_bf16_f32 v99, 0, v99
    v_cvt_pk_bf16_f32 v103, 0, v103
    v_mul_f32 v107, v95, v95
    v_mul_f32 v111, v99, v99
    v_mul_f32 v115, v103, v103
    v_cvt_pk_bf16_f32 v107, 0, v107
    v_cvt_pk_bf16_f32 v111, 0, v111
    v_cvt_pk_bf16_f32 v115, 0, v115
    v_add_f32 v107, v107, v111
    v_add_f32 v107, v107, v115
    v_cvt_pk_bf16_f32 v107, 0, v107
    v_add_f32 v107, v14, v107
    v_cvt_pk_bf16_f32 v107, 0, v107
    v_sqrt_f32 v107, v107
    v_lshl_or_b32 v78, v19, 8, v27
    v_cvt_pk_bf16_f32 v107, 0, v107
    v_rcp_f32 v111, v107
    v_cmp_gt_f32 vcc, 0x40a00000, v107
    s_sub_i32 s3, s40, 1536
    v_cmp_gt_i32 s[70:71], s3, v0
    s_nop 0
    s_and_b64 vcc, vcc, s[70:71]
    s_mov_b64 s[70:71], vcc
    s_mov_b64 exec, vcc
    ds_add_rtn_u32 v59, v55, v15
    s_mov_b64 exec, -1
    v_lshl_add_u32 v115, v107, 5, s42
    v_mul_f32 v95, v95, v111
    v_mul_f32 v99, v99, v111
    v_mul_f32 v103, v103, v111
    v_add_u32 v111, s43, v107
    v_subrev_u32 v119, 0x3ea00000, v107
    v_ashrrev_i32 v119, 31, v119
    v_bfi_b32 v115, v119, v111, v115
    v_cvt_pk_bf16_f32 v76, v95, v99
    v_cvt_pk_bf16_f32 v103, v103, 0
    v_or_b32 v77, v115, v103
A_E4:
    v_mov_b32 v126, 2324
    v_mov_b32 v127, 1
    s_mov_b64 exec, 1
    ds_add_u32 v126, v127
    s_mov_b64 exec, -1
    v_lshl_add_u32 v13, v1, 2, v13
    v_mov_b32 v11, 2324
A_HW:
    ds_read_b32 v10, v11
    s_waitcnt lgkmcnt(0)
    v_readfirstlane_b32 s3, v10
    s_nop 0
    s_cmp_ge_u32 s3, 8
    s_cbranch_scc1 A_HW_OK
    s_sleep 1
    s_branch A_HW
A_HW_OK:
    ds_read_b32 v11, v13
    s_waitcnt lgkmcnt(0)
    v_mov_b32 v12, v11
    s_nop 1
    v_add_u32_dpp v12, v12, v12 row_shr:1 row_mask:0xf bank_mask:0xf bound_ctrl:0
    s_nop 1
    v_add_u32_dpp v12, v12, v12 row_shr:2 row_mask:0xf bank_mask:0xf bound_ctrl:0
    s_nop 1
    v_add_u32_dpp v12, v12, v12 row_shr:4 row_mask:0xf bank_mask:0xf bound_ctrl:0
    s_nop 1
    v_add_u32_dpp v12, v12, v12 row_shr:8 row_mask:0xf bank_mask:0xf bound_ctrl:0
    s_nop 1
    v_add_u32_dpp v12, v12, v12 row_bcast:15 row_mask:0xa bank_mask:0xf
    s_nop 1
    v_add_u32_dpp v12, v12, v12 row_bcast:31 row_mask:0xc bank_mask:0xf
    v_sub_u32 v12, v12, v11
    ds_bpermute_b32 v48, v48, v12
    ds_bpermute_b32 v49, v49, v12
    ds_bpermute_b32 v50, v50, v12
    ds_bpermute_b32 v51, v51, v12
    v_mov_b32 v10, 88832
    s_waitcnt lgkmcnt(0)
    v_add_u32 v48, v48, v56
    v_mad_u32_u24 v48, v48, 12, v10
    s_mov_b64 exec, s[64:65]
    ds_write2_b32 v48, v64, v65 offset0:0 offset1:1
    ds_write_b32 v48, v66 offset:8
    s_mov_b64 exec, -1
    v_add_u32 v49, v49, v57
    v_mad_u32_u24 v49, v49, 12, v10
    s_mov_b64 exec, s[66:67]
    ds_write2_b32 v49, v68, v69 offset0:0 offset1:1
    ds_write_b32 v49, v70 offset:8
    s_mov_b64 exec, -1
    v_add_u32 v50, v50, v58
    v_mad_u32_u24 v50, v50, 12, v10
    s_mov_b64 exec, s[68:69]
    ds_write2_b32 v50, v72, v73 offset0:0 offset1:1
    ds_write_b32 v50, v74 offset:8
    s_mov_b64 exec, -1
    v_add_u32 v51, v51, v59
    v_mad_u32_u24 v51, v51, 12, v10
    s_mov_b64 exec, s[70:71]
    ds_write2_b32 v51, v76, v77 offset0:0 offset1:1
    ds_write_b32 v51, v78 offset:8
    s_mov_b64 exec, -1
    v_mov_b32 v126, 2328
    v_mov_b32 v127, 1
    s_mov_b64 exec, 1
    ds_add_u32 v126, v127
    s_mov_b64 exec, -1
    s_setprio 1
A_G:
    s_setprio 2
    s_lshl_b32 s3, s48, 4
    s_add_u32 s40, s3, s96
    s_lshl_b32 s3, s48, 12
    s_add_u32 s41, s3, 109312
    v_xor_b32 v12, v8, v9
    v_lshlrev_b32 v12, 4, v12
    v_lshl_add_u32 v14, v8, 8, v12
    v_add_u32 v14, s41, v14
    v_xor_b32 v20, 64, v14
    v_xor_b32 v21, 128, v14
    v_xor_b32 v22, 192, v14
    v_lshrrev_b32 v24, 2, v8
    v_and_b32 v25, 3, v8
    v_and_b32 v26, 1, v9
    v_lshl_or_b32 v27, v26, 2, v24
    v_lshl_add_u32 v28, v9, 3, v24
    v_lshlrev_b32 v28, 8, v28
    v_lshl_add_u32 v28, v25, 3, v28
    v_lshl_add_u32 v28, v27, 5, v28
    v_lshl_add_u32 v29, v9, 2, v24
    v_mul_u32_u24 v29, 192, v29
    v_lshl_add_u32 v29, v25, 3, v29
    v_add_u32 v29, 64256, v29
    v_lshl_add_u32 v30, v26, 5, v29
    v_xor_b32 v26, 1, v26
    v_lshl_add_u32 v31, v26, 5, v29
    v_lshlrev_b32 v27, 10, v9
    v_lshl_add_u32 v27, v24, 8, v27
    v_lshl_add_u32 v27, v25, 4, v27
    v_mov_b32 v11, 2340
A_WW:
    ds_read_b32 v10, v11
    s_waitcnt lgkmcnt(0)
    v_readfirstlane_b32 s3, v10
    s_nop 0
    s_cmp_ge_u32 s3, 5
    s_cbranch_scc1 A_WW_OK
    s_sleep 1
    s_branch A_WW
A_WW_OK:
    ds_read_b128 v[64:67], v14
    ds_read_b128 v[68:71], v20
    ds_read_b128 v[72:75], v21
    ds_read_b128 v[76:79], v22
    v_mov_b32 v126, 2336
    v_mov_b32 v127, 1
    s_mov_b64 exec, 1
    ds_add_u32 v126, v127
    s_mov_b64 exec, -1
    s_setprio 0
    s_cmp_lg_u32 s48, 12
    s_cbranch_scc1 A_P12
    s_setprio 1
A_P12:
    v_xor_b32 v12, 0, v28
    ds_read_b64_tr_b16 v[80:81], v12 offset:31488
    ds_read_b64_tr_b16 v[82:83], v12 offset:32512
    ds_read_b64_tr_b16 v[84:85], v12 offset:39680
    ds_read_b64_tr_b16 v[86:87], v12 offset:40704
    ds_read_b64_tr_b16 v[88:89], v12 offset:47872
    ds_read_b64_tr_b16 v[90:91], v12 offset:48896
    ds_read_b64_tr_b16 v[92:93], v12 offset:56064
    ds_read_b64_tr_b16 v[94:95], v12 offset:57088
    v_xor_b32 v13, 32, v28
    ds_read_b64_tr_b16 v[96:97], v13 offset:31488
    ds_read_b64_tr_b16 v[98:99], v13 offset:32512
    ds_read_b64_tr_b16 v[100:101], v13 offset:39680
    ds_read_b64_tr_b16 v[102:103], v13 offset:40704
    ds_read_b64_tr_b16 v[104:105], v13 offset:47872
    ds_read_b64_tr_b16 v[106:107], v13 offset:48896
    ds_read_b64_tr_b16 v[108:109], v13 offset:56064
    ds_read_b64_tr_b16 v[110:111], v13 offset:57088
    s_waitcnt lgkmcnt(8)
    v_mfma_f32_16x16x32_bf16 v[32:35], v[80:83], v[64:67], 0
    v_mfma_f32_16x16x32_bf16 v[32:35], v[84:87], v[68:71], v[32:35]
    v_mfma_f32_16x16x32_bf16 v[32:35], v[88:91], v[72:75], v[32:35]
    v_mfma_f32_16x16x32_bf16 v[32:35], v[92:95], v[76:79], v[32:35]
    v_xor_b32 v12, 64, v28
    ds_read_b64_tr_b16 v[80:81], v12 offset:31488
    ds_read_b64_tr_b16 v[82:83], v12 offset:32512
    ds_read_b64_tr_b16 v[84:85], v12 offset:39680
    ds_read_b64_tr_b16 v[86:87], v12 offset:40704
    ds_read_b64_tr_b16 v[88:89], v12 offset:47872
    ds_read_b64_tr_b16 v[90:91], v12 offset:48896
    ds_read_b64_tr_b16 v[92:93], v12 offset:56064
    ds_read_b64_tr_b16 v[94:95], v12 offset:57088
    s_waitcnt lgkmcnt(8)
    v_mfma_f32_16x16x32_bf16 v[36:39], v[96:99], v[64:67], 0
    v_mfma_f32_16x16x32_bf16 v[36:39], v[100:103], v[68:71], v[36:39]
    v_mfma_f32_16x16x32_bf16 v[36:39], v[104:107], v[72:75], v[36:39]
    v_mfma_f32_16x16x32_bf16 v[36:39], v[108:111], v[76:79], v[36:39]
    v_xor_b32 v13, 96, v28
    ds_read_b64_tr_b16 v[96:97], v13 offset:31488
    ds_read_b64_tr_b16 v[98:99], v13 offset:32512
    ds_read_b64_tr_b16 v[100:101], v13 offset:39680
    ds_read_b64_tr_b16 v[102:103], v13 offset:40704
    ds_read_b64_tr_b16 v[104:105], v13 offset:47872
    ds_read_b64_tr_b16 v[106:107], v13 offset:48896
    ds_read_b64_tr_b16 v[108:109], v13 offset:56064
    ds_read_b64_tr_b16 v[110:111], v13 offset:57088
    s_waitcnt lgkmcnt(8)
    v_mfma_f32_16x16x32_bf16 v[40:43], v[80:83], v[64:67], 0
    v_mfma_f32_16x16x32_bf16 v[40:43], v[84:87], v[68:71], v[40:43]
    v_mfma_f32_16x16x32_bf16 v[40:43], v[88:91], v[72:75], v[40:43]
    v_mfma_f32_16x16x32_bf16 v[40:43], v[92:95], v[76:79], v[40:43]
    v_xor_b32 v12, 128, v28
    ds_read_b64_tr_b16 v[80:81], v12 offset:31488
    ds_read_b64_tr_b16 v[82:83], v12 offset:32512
    ds_read_b64_tr_b16 v[84:85], v12 offset:39680
    ds_read_b64_tr_b16 v[86:87], v12 offset:40704
    ds_read_b64_tr_b16 v[88:89], v12 offset:47872
    ds_read_b64_tr_b16 v[90:91], v12 offset:48896
    ds_read_b64_tr_b16 v[92:93], v12 offset:56064
    ds_read_b64_tr_b16 v[94:95], v12 offset:57088
    s_waitcnt lgkmcnt(8)
    v_mfma_f32_16x16x32_bf16 v[44:47], v[96:99], v[64:67], 0
    v_mfma_f32_16x16x32_bf16 v[44:47], v[100:103], v[68:71], v[44:47]
    v_mfma_f32_16x16x32_bf16 v[44:47], v[104:107], v[72:75], v[44:47]
    v_mfma_f32_16x16x32_bf16 v[44:47], v[108:111], v[76:79], v[44:47]
    v_xor_b32 v13, 160, v28
    ds_read_b64_tr_b16 v[96:97], v13 offset:31488
    ds_read_b64_tr_b16 v[98:99], v13 offset:32512
    ds_read_b64_tr_b16 v[100:101], v13 offset:39680
    ds_read_b64_tr_b16 v[102:103], v13 offset:40704
    ds_read_b64_tr_b16 v[104:105], v13 offset:47872
    ds_read_b64_tr_b16 v[106:107], v13 offset:48896
    ds_read_b64_tr_b16 v[108:109], v13 offset:56064
    ds_read_b64_tr_b16 v[110:111], v13 offset:57088
    s_waitcnt lgkmcnt(8)
    v_mfma_f32_16x16x32_bf16 v[48:51], v[80:83], v[64:67], 0
    v_mfma_f32_16x16x32_bf16 v[48:51], v[84:87], v[68:71], v[48:51]
    v_mfma_f32_16x16x32_bf16 v[48:51], v[88:91], v[72:75], v[48:51]
    v_mfma_f32_16x16x32_bf16 v[48:51], v[92:95], v[76:79], v[48:51]
    v_xor_b32 v12, 192, v28
    ds_read_b64_tr_b16 v[80:81], v12 offset:31488
    ds_read_b64_tr_b16 v[82:83], v12 offset:32512
    ds_read_b64_tr_b16 v[84:85], v12 offset:39680
    ds_read_b64_tr_b16 v[86:87], v12 offset:40704
    ds_read_b64_tr_b16 v[88:89], v12 offset:47872
    ds_read_b64_tr_b16 v[90:91], v12 offset:48896
    ds_read_b64_tr_b16 v[92:93], v12 offset:56064
    ds_read_b64_tr_b16 v[94:95], v12 offset:57088
    s_waitcnt lgkmcnt(8)
    v_mfma_f32_16x16x32_bf16 v[52:55], v[96:99], v[64:67], 0
    v_mfma_f32_16x16x32_bf16 v[52:55], v[100:103], v[68:71], v[52:55]
    v_mfma_f32_16x16x32_bf16 v[52:55], v[104:107], v[72:75], v[52:55]
    v_mfma_f32_16x16x32_bf16 v[52:55], v[108:111], v[76:79], v[52:55]
    v_xor_b32 v13, 224, v28
    ds_read_b64_tr_b16 v[96:97], v13 offset:31488
    ds_read_b64_tr_b16 v[98:99], v13 offset:32512
    ds_read_b64_tr_b16 v[100:101], v13 offset:39680
    ds_read_b64_tr_b16 v[102:103], v13 offset:40704
    ds_read_b64_tr_b16 v[104:105], v13 offset:47872
    ds_read_b64_tr_b16 v[106:107], v13 offset:48896
    ds_read_b64_tr_b16 v[108:109], v13 offset:56064
    ds_read_b64_tr_b16 v[110:111], v13 offset:57088
    s_waitcnt lgkmcnt(8)
    v_mfma_f32_16x16x32_bf16 v[56:59], v[80:83], v[64:67], 0
    v_mfma_f32_16x16x32_bf16 v[56:59], v[84:87], v[68:71], v[56:59]
    v_mfma_f32_16x16x32_bf16 v[56:59], v[88:91], v[72:75], v[56:59]
    v_mfma_f32_16x16x32_bf16 v[56:59], v[92:95], v[76:79], v[56:59]
    s_waitcnt lgkmcnt(0)
    v_mfma_f32_16x16x32_bf16 v[60:63], v[96:99], v[64:67], 0
    v_mfma_f32_16x16x32_bf16 v[60:63], v[100:103], v[68:71], v[60:63]
    v_mfma_f32_16x16x32_bf16 v[60:63], v[104:107], v[72:75], v[60:63]
    v_mfma_f32_16x16x32_bf16 v[60:63], v[108:111], v[76:79], v[60:63]
    v_mov_b32 v11, 2364
A_W2W:
    ds_read_b32 v10, v11
    s_waitcnt lgkmcnt(0)
    v_readfirstlane_b32 s3, v10
    s_nop 0
    s_cmp_ge_u32 s3, 5
    s_cbranch_scc1 A_W2W_OK
    s_sleep 1
    s_branch A_W2W
A_W2W_OK:
    ds_read_b64_tr_b16 v[80:81], v30 offset:0
    ds_read_b64_tr_b16 v[82:83], v30 offset:3072
    ds_read_b64_tr_b16 v[84:85], v30 offset:6144
    ds_read_b64_tr_b16 v[86:87], v30 offset:9216
    ds_read_b64_tr_b16 v[88:89], v30 offset:12288
    ds_read_b64_tr_b16 v[90:91], v30 offset:15360
    ds_read_b64_tr_b16 v[92:93], v30 offset:18432
    ds_read_b64_tr_b16 v[94:95], v30 offset:21504
    v_mov_b32 v12, 0xbfb8aa3b
    v_cvt_pk_bf16_f32 v32, 0, v32
    v_cvt_pk_bf16_f32 v33, 0, v33
    v_cvt_pk_bf16_f32 v34, 0, v34
    v_cvt_pk_bf16_f32 v35, 0, v35
    v_cvt_pk_bf16_f32 v36, 0, v36
    v_cvt_pk_bf16_f32 v37, 0, v37
    v_cvt_pk_bf16_f32 v38, 0, v38
    v_cvt_pk_bf16_f32 v39, 0, v39
    v_mul_f32 v96, v12, v32
    v_mul_f32 v97, v12, v33
    v_mul_f32 v98, v12, v34
    v_mul_f32 v99, v12, v35
    v_mul_f32 v100, v12, v36
    v_mul_f32 v101, v12, v37
    v_mul_f32 v102, v12, v38
    v_mul_f32 v103, v12, v39
    v_exp_f32 v96, v96
    v_exp_f32 v97, v97
    v_exp_f32 v98, v98
    v_exp_f32 v99, v99
    v_exp_f32 v100, v100
    v_exp_f32 v101, v101
    v_exp_f32 v102, v102
    v_exp_f32 v103, v103
    v_add_f32 v96, 1.0, v96
    v_add_f32 v97, 1.0, v97
    v_add_f32 v98, 1.0, v98
    v_add_f32 v99, 1.0, v99
    v_add_f32 v100, 1.0, v100
    v_add_f32 v101, 1.0, v101
    v_add_f32 v102, 1.0, v102
    v_add_f32 v103, 1.0, v103
    v_rcp_f32 v96, v96
    v_rcp_f32 v97, v97
    v_rcp_f32 v98, v98
    v_rcp_f32 v99, v99
    v_rcp_f32 v100, v100
    v_rcp_f32 v101, v101
    v_rcp_f32 v102, v102
    v_rcp_f32 v103, v103
    v_mul_f32 v32, v32, v96
    v_mul_f32 v33, v33, v97
    v_mul_f32 v34, v34, v98
    v_mul_f32 v35, v35, v99
    v_mul_f32 v36, v36, v100
    v_mul_f32 v37, v37, v101
    v_mul_f32 v38, v38, v102
    v_mul_f32 v39, v39, v103
    v_cvt_pk_bf16_f32 v64, v32, v33
    v_cvt_pk_bf16_f32 v65, v34, v35
    v_cvt_pk_bf16_f32 v66, v36, v37
    v_cvt_pk_bf16_f32 v67, v38, v39
    v_cvt_pk_bf16_f32 v40, 0, v40
    v_cvt_pk_bf16_f32 v41, 0, v41
    v_cvt_pk_bf16_f32 v42, 0, v42
    v_cvt_pk_bf16_f32 v43, 0, v43
    v_cvt_pk_bf16_f32 v44, 0, v44
    v_cvt_pk_bf16_f32 v45, 0, v45
    v_cvt_pk_bf16_f32 v46, 0, v46
    v_cvt_pk_bf16_f32 v47, 0, v47
    v_mul_f32 v96, v12, v40
    v_mul_f32 v97, v12, v41
    v_mul_f32 v98, v12, v42
    v_mul_f32 v99, v12, v43
    v_mul_f32 v100, v12, v44
    v_mul_f32 v101, v12, v45
    v_mul_f32 v102, v12, v46
    v_mul_f32 v103, v12, v47
    v_exp_f32 v96, v96
    v_exp_f32 v97, v97
    v_exp_f32 v98, v98
    v_exp_f32 v99, v99
    v_exp_f32 v100, v100
    v_exp_f32 v101, v101
    v_exp_f32 v102, v102
    v_exp_f32 v103, v103
    v_add_f32 v96, 1.0, v96
    v_add_f32 v97, 1.0, v97
    v_add_f32 v98, 1.0, v98
    v_add_f32 v99, 1.0, v99
    v_add_f32 v100, 1.0, v100
    v_add_f32 v101, 1.0, v101
    v_add_f32 v102, 1.0, v102
    v_add_f32 v103, 1.0, v103
    v_rcp_f32 v96, v96
    v_rcp_f32 v97, v97
    v_rcp_f32 v98, v98
    v_rcp_f32 v99, v99
    v_rcp_f32 v100, v100
    v_rcp_f32 v101, v101
    v_rcp_f32 v102, v102
    v_rcp_f32 v103, v103
    v_mul_f32 v40, v40, v96
    v_mul_f32 v41, v41, v97
    v_mul_f32 v42, v42, v98
    v_mul_f32 v43, v43, v99
    v_mul_f32 v44, v44, v100
    v_mul_f32 v45, v45, v101
    v_mul_f32 v46, v46, v102
    v_mul_f32 v47, v47, v103
    v_cvt_pk_bf16_f32 v68, v40, v41
    v_cvt_pk_bf16_f32 v69, v42, v43
    v_cvt_pk_bf16_f32 v70, v44, v45
    v_cvt_pk_bf16_f32 v71, v46, v47
    v_cvt_pk_bf16_f32 v48, 0, v48
    v_cvt_pk_bf16_f32 v49, 0, v49
    v_cvt_pk_bf16_f32 v50, 0, v50
    v_cvt_pk_bf16_f32 v51, 0, v51
    v_cvt_pk_bf16_f32 v52, 0, v52
    v_cvt_pk_bf16_f32 v53, 0, v53
    v_cvt_pk_bf16_f32 v54, 0, v54
    v_cvt_pk_bf16_f32 v55, 0, v55
    v_mul_f32 v96, v12, v48
    v_mul_f32 v97, v12, v49
    v_mul_f32 v98, v12, v50
    v_mul_f32 v99, v12, v51
    v_mul_f32 v100, v12, v52
    v_mul_f32 v101, v12, v53
    v_mul_f32 v102, v12, v54
    v_mul_f32 v103, v12, v55
    v_exp_f32 v96, v96
    v_exp_f32 v97, v97
    v_exp_f32 v98, v98
    v_exp_f32 v99, v99
    v_exp_f32 v100, v100
    v_exp_f32 v101, v101
    v_exp_f32 v102, v102
    v_exp_f32 v103, v103
    v_add_f32 v96, 1.0, v96
    v_add_f32 v97, 1.0, v97
    v_add_f32 v98, 1.0, v98
    v_add_f32 v99, 1.0, v99
    v_add_f32 v100, 1.0, v100
    v_add_f32 v101, 1.0, v101
    v_add_f32 v102, 1.0, v102
    v_add_f32 v103, 1.0, v103
    v_rcp_f32 v96, v96
    v_rcp_f32 v97, v97
    v_rcp_f32 v98, v98
    v_rcp_f32 v99, v99
    v_rcp_f32 v100, v100
    v_rcp_f32 v101, v101
    v_rcp_f32 v102, v102
    v_rcp_f32 v103, v103
    v_mul_f32 v48, v48, v96
    v_mul_f32 v49, v49, v97
    v_mul_f32 v50, v50, v98
    v_mul_f32 v51, v51, v99
    v_mul_f32 v52, v52, v100
    v_mul_f32 v53, v53, v101
    v_mul_f32 v54, v54, v102
    v_mul_f32 v55, v55, v103
    v_cvt_pk_bf16_f32 v72, v48, v49
    v_cvt_pk_bf16_f32 v73, v50, v51
    v_cvt_pk_bf16_f32 v74, v52, v53
    v_cvt_pk_bf16_f32 v75, v54, v55
    v_cvt_pk_bf16_f32 v56, 0, v56
    v_cvt_pk_bf16_f32 v57, 0, v57
    v_cvt_pk_bf16_f32 v58, 0, v58
    v_cvt_pk_bf16_f32 v59, 0, v59
    v_cvt_pk_bf16_f32 v60, 0, v60
    v_cvt_pk_bf16_f32 v61, 0, v61
    v_cvt_pk_bf16_f32 v62, 0, v62
    v_cvt_pk_bf16_f32 v63, 0, v63
    v_mul_f32 v96, v12, v56
    v_mul_f32 v97, v12, v57
    v_mul_f32 v98, v12, v58
    v_mul_f32 v99, v12, v59
    v_mul_f32 v100, v12, v60
    v_mul_f32 v101, v12, v61
    v_mul_f32 v102, v12, v62
    v_mul_f32 v103, v12, v63
    v_exp_f32 v96, v96
    v_exp_f32 v97, v97
    v_exp_f32 v98, v98
    v_exp_f32 v99, v99
    v_exp_f32 v100, v100
    v_exp_f32 v101, v101
    v_exp_f32 v102, v102
    v_exp_f32 v103, v103
    v_add_f32 v96, 1.0, v96
    v_add_f32 v97, 1.0, v97
    v_add_f32 v98, 1.0, v98
    v_add_f32 v99, 1.0, v99
    v_add_f32 v100, 1.0, v100
    v_add_f32 v101, 1.0, v101
    v_add_f32 v102, 1.0, v102
    v_add_f32 v103, 1.0, v103
    v_rcp_f32 v96, v96
    v_rcp_f32 v97, v97
    v_rcp_f32 v98, v98
    v_rcp_f32 v99, v99
    v_rcp_f32 v100, v100
    v_rcp_f32 v101, v101
    v_rcp_f32 v102, v102
    v_rcp_f32 v103, v103
    v_mul_f32 v56, v56, v96
    v_mul_f32 v57, v57, v97
    v_mul_f32 v58, v58, v98
    v_mul_f32 v59, v59, v99
    v_mul_f32 v60, v60, v100
    v_mul_f32 v61, v61, v101
    v_mul_f32 v62, v62, v102
    v_mul_f32 v63, v63, v103
    v_cvt_pk_bf16_f32 v76, v56, v57
    v_cvt_pk_bf16_f32 v77, v58, v59
    v_cvt_pk_bf16_f32 v78, v60, v61
    v_cvt_pk_bf16_f32 v79, v62, v63
    ds_read_b64_tr_b16 v[96:97], v31 offset:0
    ds_read_b64_tr_b16 v[98:99], v31 offset:3072
    ds_read_b64_tr_b16 v[100:101], v31 offset:6144
    ds_read_b64_tr_b16 v[102:103], v31 offset:9216
    ds_read_b64_tr_b16 v[104:105], v31 offset:12288
    ds_read_b64_tr_b16 v[106:107], v31 offset:15360
    ds_read_b64_tr_b16 v[108:109], v31 offset:18432
    ds_read_b64_tr_b16 v[110:111], v31 offset:21504
    s_waitcnt lgkmcnt(8)
    v_mfma_f32_16x16x32_bf16 v[36:39], v[64:67], v[80:83], 0
    v_mfma_f32_16x16x32_bf16 v[36:39], v[68:71], v[84:87], v[36:39]
    v_mfma_f32_16x16x32_bf16 v[36:39], v[72:75], v[88:91], v[36:39]
    v_mfma_f32_16x16x32_bf16 v[36:39], v[76:79], v[92:95], v[36:39]
    ds_read_b64_tr_b16 v[80:81], v30 offset:64
    ds_read_b64_tr_b16 v[82:83], v30 offset:3136
    ds_read_b64_tr_b16 v[84:85], v30 offset:6208
    ds_read_b64_tr_b16 v[86:87], v30 offset:9280
    ds_read_b64_tr_b16 v[88:89], v30 offset:12352
    ds_read_b64_tr_b16 v[90:91], v30 offset:15424
    ds_read_b64_tr_b16 v[92:93], v30 offset:18496
    ds_read_b64_tr_b16 v[94:95], v30 offset:21568
    s_waitcnt lgkmcnt(8)
    v_mfma_f32_16x16x32_bf16 v[40:43], v[64:67], v[96:99], 0
    v_mfma_f32_16x16x32_bf16 v[40:43], v[68:71], v[100:103], v[40:43]
    v_mfma_f32_16x16x32_bf16 v[40:43], v[72:75], v[104:107], v[40:43]
    v_mfma_f32_16x16x32_bf16 v[40:43], v[76:79], v[108:111], v[40:43]
    ds_read_b64_tr_b16 v[96:97], v31 offset:64
    ds_read_b64_tr_b16 v[98:99], v31 offset:3136
    ds_read_b64_tr_b16 v[100:101], v31 offset:6208
    ds_read_b64_tr_b16 v[102:103], v31 offset:9280
    ds_read_b64_tr_b16 v[104:105], v31 offset:12352
    ds_read_b64_tr_b16 v[106:107], v31 offset:15424
    ds_read_b64_tr_b16 v[108:109], v31 offset:18496
    ds_read_b64_tr_b16 v[110:111], v31 offset:21568
    s_waitcnt lgkmcnt(8)
    v_mfma_f32_16x16x32_bf16 v[112:115], v[64:67], v[80:83], 0
    v_mfma_f32_16x16x32_bf16 v[112:115], v[68:71], v[84:87], v[112:115]
    v_mfma_f32_16x16x32_bf16 v[112:115], v[72:75], v[88:91], v[112:115]
    v_mfma_f32_16x16x32_bf16 v[112:115], v[76:79], v[92:95], v[112:115]
    ds_read_b64_tr_b16 v[80:81], v30 offset:128
    ds_read_b64_tr_b16 v[82:83], v30 offset:3200
    ds_read_b64_tr_b16 v[84:85], v30 offset:6272
    ds_read_b64_tr_b16 v[86:87], v30 offset:9344
    ds_read_b64_tr_b16 v[88:89], v30 offset:12416
    ds_read_b64_tr_b16 v[90:91], v30 offset:15488
    ds_read_b64_tr_b16 v[92:93], v30 offset:18560
    ds_read_b64_tr_b16 v[94:95], v30 offset:21632
    s_waitcnt lgkmcnt(8)
    v_mfma_f32_16x16x32_bf16 v[116:119], v[64:67], v[96:99], 0
    v_mfma_f32_16x16x32_bf16 v[116:119], v[68:71], v[100:103], v[116:119]
    v_mfma_f32_16x16x32_bf16 v[116:119], v[72:75], v[104:107], v[116:119]
    v_mfma_f32_16x16x32_bf16 v[116:119], v[76:79], v[108:111], v[116:119]
    ds_read_b64_tr_b16 v[96:97], v31 offset:128
    ds_read_b64_tr_b16 v[98:99], v31 offset:3200
    ds_read_b64_tr_b16 v[100:101], v31 offset:6272
    ds_read_b64_tr_b16 v[102:103], v31 offset:9344
    ds_read_b64_tr_b16 v[104:105], v31 offset:12416
    ds_read_b64_tr_b16 v[106:107], v31 offset:15488
    ds_read_b64_tr_b16 v[108:109], v31 offset:18560
    ds_read_b64_tr_b16 v[110:111], v31 offset:21632
    s_waitcnt lgkmcnt(8)
    v_mfma_f32_16x16x32_bf16 v[120:123], v[64:67], v[80:83], 0
    v_mfma_f32_16x16x32_bf16 v[120:123], v[68:71], v[84:87], v[120:123]
    v_mfma_f32_16x16x32_bf16 v[120:123], v[72:75], v[88:91], v[120:123]
    v_mfma_f32_16x16x32_bf16 v[120:123], v[76:79], v[92:95], v[120:123]
    s_waitcnt lgkmcnt(0)
    v_mfma_f32_16x16x32_bf16 v[124:127], v[64:67], v[96:99], 0
    v_mfma_f32_16x16x32_bf16 v[124:127], v[68:71], v[100:103], v[124:127]
    v_mfma_f32_16x16x32_bf16 v[124:127], v[72:75], v[104:107], v[124:127]
    v_mfma_f32_16x16x32_bf16 v[124:127], v[76:79], v[108:111], v[124:127]
    s_lshl_b32 s42, s40, 8
    s_mul_i32 s3, s49, 3211264
    s_add_u32 s42, s42, s3
    s_lshl_b32 s43, s40, 7
    s_and_b32 s3, s49, 1
    s_lshl_b32 s3, s3, 6
    s_add_u32 s43, s43, s3
    s_lshr_b32 s3, s49, 1
    s_mul_i32 s3, s3, 1605632
    s_add_u32 s43, s43, s3
    s_add_u32 s43, s43, 12845056
    v_lshlrev_b32 v12, 10, v9
    v_lshl_add_u32 v13, v8, 2, v12
    v_add_u32 v13, s41, v13
    v_lshl_add_u32 v12, v8, 4, v12
    v_lshlrev_b32 v14, 9, v9
    v_lshl_add_u32 v14, v8, 2, v14
    v_add_u32 v12, s42, v12
    v_add_u32 v14, s43, v14
    s_cmp_eq_u32 s48, 12
    s_cselect_b32 s46, 0xffff, -1
    s_cselect_b32 s47, 0, -1
    v_mov_b32 v10, 2368
    v_mov_b32 v11, 1
    s_mov_b64 exec, 1
    ds_add_u32 v10, v11
    s_mov_b64 exec, -1
    s_mov_b32 s92, 0x07060302
    v_mov_b32 v15, 0x0d800000
    v_add_f32 v40, v40, v15
    v_add_f32 v41, v41, v15
    v_add_f32 v42, v42, v15
    v_add_f32 v43, v43, v15
    v_cvt_pk_bf16_f32 v36, -v36, v36
    v_cvt_pk_bf16_f32 v37, -v37, v37
    v_cvt_pk_bf16_f32 v38, -v38, v38
    v_cvt_pk_bf16_f32 v39, -v39, v39
    v_cvt_pk_bf16_f32 v40, 0, v40
    v_cvt_pk_bf16_f32 v41, 0, v41
    v_cvt_pk_bf16_f32 v42, 0, v42
    v_cvt_pk_bf16_f32 v43, 0, v43
    v_sub_u32_sdwa v40, v40, sext(v36) dst_sel:DWORD dst_unused:UNUSED_PAD src0_sel:DWORD src1_sel:WORD_0
    v_sub_u32_sdwa v41, v41, sext(v37) dst_sel:DWORD dst_unused:UNUSED_PAD src0_sel:DWORD src1_sel:WORD_0
    v_sub_u32_sdwa v42, v42, sext(v38) dst_sel:DWORD dst_unused:UNUSED_PAD src0_sel:DWORD src1_sel:WORD_0
    v_sub_u32_sdwa v43, v43, sext(v39) dst_sel:DWORD dst_unused:UNUSED_PAD src0_sel:DWORD src1_sel:WORD_0
    v_perm_b32 v36, v40, v36, s92
    v_perm_b32 v37, v41, v37, s92
    v_perm_b32 v38, v42, v38, s92
    v_perm_b32 v39, v43, v39, s92
    s_mov_b32 s88, s32
    s_mov_b32 s89, s33
    s_mov_b32 s90, 0xf50000
    s_mov_b32 s91, 0x20000
    s_mov_b64 exec, s[46:47]
    buffer_store_dword v36, v14, s[88:91], 0 offen offset:0 sc0 sc1
    buffer_store_dword v37, v14, s[88:91], 0 offen offset:128 sc0 sc1
    buffer_store_dword v38, v14, s[88:91], 0 offen offset:256 sc0 sc1
    buffer_store_dword v39, v14, s[88:91], 0 offen offset:384 sc0 sc1
    s_mov_b64 exec, -1
    s_mov_b32 s42, 0x654f3210
    s_mov_b32 s43, 0x7ffff
    s_lshl_b32 s3, s48, 2
    s_lshr_b64 s[42:43], s[42:43], s3
    s_and_b32 s26, s42, 15
    s_cmp_lt_u32 s26, 8
    s_cbranch_scc0 A_NR0
    v_mov_b32 v11, 2312
A_RW:
    ds_read_b32 v10, v11
    s_waitcnt lgkmcnt(0)
    v_readfirstlane_b32 s3, v10
    s_nop 0
    s_cmp_ge_u32 s3, 1
    s_cbranch_scc1 A_RW_OK
    s_sleep 4
    s_branch A_RW
A_RW_OK:
    s_mov_b32 s95, 0
    v_mov_b32 v62, 0
    v_mov_b32 v63, 0
    v_mov_b32 v35, 0
    s_cmp_ge_u32 s26, 11
    s_cbranch_scc1 RL3
    s_lshl_b32 s3, s26, 3
    v_lshrrev_b32 v5, 3, v1
    v_add_u32 v5, s3, v5
    v_lshlrev_b32 v6, 2, v5
    ds_read_b32 v32, v6 offset:3072
    ds_read_b32 v33, v6 offset:3424
    ds_read_b32 v34, v6 offset:3776
    v_mul_u32_u24 v5, 18816, v5
    v_and_b32 v6, 7, v1
    v_add_u32 v7, s51, v6
    v_mad_u32_u24 v5, v7, 12, v5
    s_cmp_eq_u32 s26, 10
    s_cselect_b32 s3, 0, -1
    s_waitcnt lgkmcnt(0)
    v_and_b32 v34, s3, v34
    v_and_b32 v7, 0xffff, v32
    v_mad_u32_u24 v62, v7, 12, v5
    v_lshrrev_b32 v32, 16, v32
    v_subrev_u32 v32, s51, v32
    v_min_i32 v32, s52, v32
    v_sub_u32 v32, v32, v6
    v_and_b32 v7, 0xffff, v33
    v_mad_u32_u24 v63, v7, 12, v5
    v_lshrrev_b32 v33, 16, v33
    v_subrev_u32 v33, s51, v33
    v_min_i32 v33, s52, v33
    v_sub_u32 v33, v33, v6
    v_and_b32 v7, 0xffff, v34
    v_mad_u32_u24 v35, v7, 12, v5
    v_lshrrev_b32 v34, 16, v34
    v_subrev_u32 v34, s51, v34
    v_min_i32 v34, s52, v34
    v_sub_u32 v34, v34, v6
    v_cmp_lt_i32 s[64:65], 0, v32
    v_cmp_lt_i32 s[66:67], 0, v33
    v_cmp_lt_i32 s[68:69], 0, v34
    v_cmp_lt_i32 s[70:71], 8, v32
    v_cmp_lt_i32 s[72:73], 8, v33
    v_cmp_lt_i32 s[74:75], 8, v34
    v_cmp_lt_i32 s[76:77], 16, v32
    v_cmp_lt_i32 s[78:79], 16, v33
    v_cmp_lt_i32 s[80:81], 16, v34
    v_cmp_lt_i32 s[82:83], 24, v32
    v_cmp_lt_i32 s[84:85], 24, v33
    v_cmp_lt_i32 s[86:87], 24, v34
    v_max3_i32 v7, v32, v33, v34
    s_mov_b32 s95, 6
    v_cmp_lt_i32 vcc, 16, v7
    s_nop 0
    s_cmp_lg_u64 vcc, 0
    s_cselect_b32 s95, 9, s95
    v_cmp_lt_i32 vcc, 24, v7
    s_nop 0
    s_cmp_lg_u64 vcc, 0
    s_cselect_b32 s95, 12, s95
    v_cmp_lt_i32 vcc, 32, v7
    s_nop 0
    s_cmp_lg_u64 vcc, 0
    s_cselect_b32 s95, 15, s95
    v_cmp_lt_i32 vcc, 40, v7
    s_nop 0
    s_cmp_lg_u64 vcc, 0
    s_cselect_b32 s95, 18, s95
    s_cmp_le_u32 s95, 0
    s_cbranch_scc1 FS4
    s_mov_b32 s3, 196608
    s_mov_b64 exec, s[64:65]
    buffer_load_dwordx3 v[64:66], v62, s[20:23], s3 offen offset:0 sc1
    s_mov_b32 s3, 1852416
    s_mov_b64 exec, s[66:67]
    buffer_load_dwordx3 v[68:70], v63, s[20:23], s3 offen offset:0 sc1
    s_mov_b32 s3, 3508224
    s_mov_b64 exec, s[68:69]
    buffer_load_dwordx3 v[72:74], v35, s[20:23], s3 offen offset:0 sc1
    s_mov_b32 s3, 196608
    s_mov_b64 exec, s[70:71]
    buffer_load_dwordx3 v[76:78], v62, s[20:23], s3 offen offset:96 sc1
    s_mov_b32 s3, 1852416
    s_mov_b64 exec, s[72:73]
    buffer_load_dwordx3 v[80:82], v63, s[20:23], s3 offen offset:96 sc1
    s_mov_b32 s3, 3508224
    s_mov_b64 exec, s[74:75]
    buffer_load_dwordx3 v[84:86], v35, s[20:23], s3 offen offset:96 sc1
    s_cmp_le_u32 s95, 6
    s_cbranch_scc1 FS4
    s_mov_b32 s3, 196608
    s_mov_b64 exec, s[76:77]
    buffer_load_dwordx3 v[88:90], v62, s[20:23], s3 offen offset:192 sc1
    s_mov_b32 s3, 1852416
    s_mov_b64 exec, s[78:79]
    buffer_load_dwordx3 v[92:94], v63, s[20:23], s3 offen offset:192 sc1
    s_mov_b32 s3, 3508224
    s_mov_b64 exec, s[80:81]
    buffer_load_dwordx3 v[96:98], v35, s[20:23], s3 offen offset:192 sc1
    s_cmp_le_u32 s95, 9
    s_cbranch_scc1 FS4
    s_mov_b32 s3, 196608
    s_mov_b64 exec, s[82:83]
    buffer_load_dwordx3 v[100:102], v62, s[20:23], s3 offen offset:288 sc1
    s_mov_b32 s3, 1852416
    s_mov_b64 exec, s[84:85]
    buffer_load_dwordx3 v[104:106], v63, s[20:23], s3 offen offset:288 sc1
    s_mov_b32 s3, 3508224
    s_mov_b64 exec, s[86:87]
    buffer_load_dwordx3 v[108:110], v35, s[20:23], s3 offen offset:288 sc1
FS4:
    s_mov_b64 exec, -1
RL3:
    v_mov_b32 v10, 2376
    v_mov_b32 v11, 1
    s_mov_b64 exec, 1
    ds_add_u32 v10, v11
    s_mov_b64 exec, -1
    s_branch A_NRL
A_NR0:
    s_mov_b32 s95, 0
    v_mov_b32 v62, 0
    v_mov_b32 v63, 0
    v_mov_b32 v35, 0
A_NRL:
    s_mov_b32 s27, 1
    s_cmp_ge_u32 s26, 8
    s_cbranch_scc1 A_STN
    s_cmp_le_u32 s95, 12
    s_cbranch_scc1 A_W0
A_STN:
    s_cmp_lt_u32 s26, 8
    s_cbranch_scc1 A_ST2
    s_waitcnt vmcnt(0)
    v_mov_b32 v10, 2380
    v_mov_b32 v11, 1
    s_mov_b64 exec, 1
    ds_add_u32 v10, v11
    s_mov_b64 exec, -1
A_ST2:
    v_mov_b32 v11, 2376
A_IW:
    ds_read_b32 v10, v11
    s_waitcnt lgkmcnt(0)
    v_readfirstlane_b32 s3, v10
    s_nop 0
    s_cmp_ge_u32 s3, 11
    s_cbranch_scc1 A_IW_OK
    s_sleep 1
    s_branch A_IW
A_IW_OK:
    s_cmp_lg_u32 s48, 11
    s_cbranch_scc1 A_NPS
    s_setprio 3
    v_mov_b32 v6, 2380
A_SDW:
    ds_read_b32 v5, v6
    s_waitcnt lgkmcnt(0)
    v_readfirstlane_b32 s3, v5
    s_nop 0
    s_cmp_ge_u32 s3, 13
    s_cbranch_scc1 A_SDW_OK
    s_sleep 1
    s_branch A_SDW
A_SDW_OK:
    v_mov_b32 v35, 2372
    ds_read_b32 v35, v35
    s_waitcnt lgkmcnt(0)
    v_lshlrev_b32 v5, 10, v1
    s_lshl_b32 s42, s49, 6
    s_add_u32 s42, s42, s50
    s_lshl_b32 s42, s42, 2
    s_add_u32 s42, s42, 139264
    s_mov_b64 exec, 0xff
    buffer_store_dword v35, v5, s[20:23], s42 offen sc0 sc1
    s_mov_b64 exec, -1
A_NPS:
    v_mov_b32 v11, 2348
A_VW:
    ds_read_b32 v10, v11
    s_waitcnt lgkmcnt(0)
    v_readfirstlane_b32 s3, v10
    s_nop 0
    s_cmp_ge_u32 s3, 2
    s_cbranch_scc1 A_VW_OK
    s_sleep 2
    s_branch A_VW
A_VW_OK:
    ds_read_b32 v36, v13 offset:0
    ds_read_b32 v37, v13 offset:64
    ds_read_b32 v38, v13 offset:128
    ds_read_b32 v40, v13 offset:256
    ds_read_b32 v41, v13 offset:320
    ds_read_b32 v42, v13 offset:384
    ds_read_b32 v24, v13 offset:512
    ds_read_b32 v25, v13 offset:576
    ds_read_b32 v26, v13 offset:640
    ds_read_b32 v16, v13 offset:768
    ds_read_b32 v17, v13 offset:832
    ds_read_b32 v18, v13 offset:896
    s_mov_b32 s88, s32
    s_mov_b32 s89, s33
    s_mov_b32 s90, 0xf50000
    s_mov_b32 s91, 0x20000
    s_mov_b32 s3, 0x07060302
    v_mov_b32 v15, 0x0d800000
    s_waitcnt lgkmcnt(0)
    v_cvt_pk_bf16_f32 v10, 0, v112
    v_cvt_pk_bf16_f32 v11, 0, v116
    v_add_f32 v4, v124, v15
    v_lshlrev_b32 v5, 16, v36
    v_lshlrev_b32 v6, 16, v37
    v_lshlrev_b32 v7, 16, v38
    v_and_b32 v9, 0xffff0000, v36
    v_and_b32 v14, 0xffff0000, v37
    v_and_b32 v20, 0xffff0000, v38
    v_cvt_pk_bf16_f32 v4, 0, v4
    v_mul_f32 v5, v5, v10
    v_mul_f32 v6, v6, v10
    v_mul_f32 v7, v7, v10
    v_fma_f32 v9, v9, v11, v15
    v_fma_f32 v14, v14, v11, v15
    v_fma_f32 v20, v20, v11, v15
    v_cvt_pk_bf16_f32 v8, -v120, v120
    v_cvt_pk_bf16_f32 v5, -v5, v5
    v_cvt_pk_bf16_f32 v6, -v6, v6
    v_cvt_pk_bf16_f32 v7, -v7, v7
    v_sub_u32_sdwa v4, v4, sext(v8) dst_sel:DWORD dst_unused:UNUSED_PAD src0_sel:DWORD src1_sel:WORD_0
    v_sub_u32_sdwa v9, v9, sext(v5) dst_sel:DWORD dst_unused:UNUSED_PAD src0_sel:DWORD src1_sel:WORD_0
    v_sub_u32_sdwa v14, v14, sext(v6) dst_sel:DWORD dst_unused:UNUSED_PAD src0_sel:DWORD src1_sel:WORD_0
    v_sub_u32_sdwa v20, v20, sext(v7) dst_sel:DWORD dst_unused:UNUSED_PAD src0_sel:DWORD src1_sel:WORD_0
    v_perm_b32 v39, v4, v8, s3
    v_perm_b32 v36, v9, v5, s3
    v_perm_b32 v37, v14, v6, s3
    v_perm_b32 v38, v20, v7, s3
    v_cvt_pk_bf16_f32 v10, 0, v113
    v_cvt_pk_bf16_f32 v11, 0, v117
    v_add_f32 v4, v125, v15
    v_lshlrev_b32 v5, 16, v40
    v_lshlrev_b32 v6, 16, v41
    v_lshlrev_b32 v7, 16, v42
    v_and_b32 v9, 0xffff0000, v40
    v_and_b32 v14, 0xffff0000, v41
    v_and_b32 v20, 0xffff0000, v42
    v_cvt_pk_bf16_f32 v4, 0, v4
    v_mul_f32 v5, v5, v10
    v_mul_f32 v6, v6, v10
    v_mul_f32 v7, v7, v10
    v_fma_f32 v9, v9, v11, v15
    v_fma_f32 v14, v14, v11, v15
    v_fma_f32 v20, v20, v11, v15
    v_cvt_pk_bf16_f32 v8, -v121, v121
    v_cvt_pk_bf16_f32 v5, -v5, v5
    v_cvt_pk_bf16_f32 v6, -v6, v6
    v_cvt_pk_bf16_f32 v7, -v7, v7
    v_sub_u32_sdwa v4, v4, sext(v8) dst_sel:DWORD dst_unused:UNUSED_PAD src0_sel:DWORD src1_sel:WORD_0
    v_sub_u32_sdwa v9, v9, sext(v5) dst_sel:DWORD dst_unused:UNUSED_PAD src0_sel:DWORD src1_sel:WORD_0
    v_sub_u32_sdwa v14, v14, sext(v6) dst_sel:DWORD dst_unused:UNUSED_PAD src0_sel:DWORD src1_sel:WORD_0
    v_sub_u32_sdwa v20, v20, sext(v7) dst_sel:DWORD dst_unused:UNUSED_PAD src0_sel:DWORD src1_sel:WORD_0
    v_perm_b32 v43, v4, v8, s3
    v_perm_b32 v40, v9, v5, s3
    v_perm_b32 v41, v14, v6, s3
    v_perm_b32 v42, v20, v7, s3
    v_cvt_pk_bf16_f32 v10, 0, v114
    v_cvt_pk_bf16_f32 v11, 0, v118
    v_add_f32 v4, v126, v15
    v_lshlrev_b32 v5, 16, v24
    v_lshlrev_b32 v6, 16, v25
    v_lshlrev_b32 v7, 16, v26
    v_and_b32 v9, 0xffff0000, v24
    v_and_b32 v14, 0xffff0000, v25
    v_and_b32 v20, 0xffff0000, v26
    v_cvt_pk_bf16_f32 v4, 0, v4
    v_mul_f32 v5, v5, v10
    v_mul_f32 v6, v6, v10
    v_mul_f32 v7, v7, v10
    v_fma_f32 v9, v9, v11, v15
    v_fma_f32 v14, v14, v11, v15
    v_fma_f32 v20, v20, v11, v15
    v_cvt_pk_bf16_f32 v8, -v122, v122
    v_cvt_pk_bf16_f32 v5, -v5, v5
    v_cvt_pk_bf16_f32 v6, -v6, v6
    v_cvt_pk_bf16_f32 v7, -v7, v7
    v_sub_u32_sdwa v4, v4, sext(v8) dst_sel:DWORD dst_unused:UNUSED_PAD src0_sel:DWORD src1_sel:WORD_0
    v_sub_u32_sdwa v9, v9, sext(v5) dst_sel:DWORD dst_unused:UNUSED_PAD src0_sel:DWORD src1_sel:WORD_0
    v_sub_u32_sdwa v14, v14, sext(v6) dst_sel:DWORD dst_unused:UNUSED_PAD src0_sel:DWORD src1_sel:WORD_0
    v_sub_u32_sdwa v20, v20, sext(v7) dst_sel:DWORD dst_unused:UNUSED_PAD src0_sel:DWORD src1_sel:WORD_0
    v_perm_b32 v27, v4, v8, s3
    v_perm_b32 v24, v9, v5, s3
    v_perm_b32 v25, v14, v6, s3
    v_perm_b32 v26, v20, v7, s3
    v_cvt_pk_bf16_f32 v10, 0, v115
    v_cvt_pk_bf16_f32 v11, 0, v119
    v_add_f32 v4, v127, v15
    v_lshlrev_b32 v5, 16, v16
    v_lshlrev_b32 v6, 16, v17
    v_lshlrev_b32 v7, 16, v18
    v_and_b32 v9, 0xffff0000, v16
    v_and_b32 v14, 0xffff0000, v17
    v_and_b32 v20, 0xffff0000, v18
    v_cvt_pk_bf16_f32 v4, 0, v4
    v_mul_f32 v5, v5, v10
    v_mul_f32 v6, v6, v10
    v_mul_f32 v7, v7, v10
    v_fma_f32 v9, v9, v11, v15
    v_fma_f32 v14, v14, v11, v15
    v_fma_f32 v20, v20, v11, v15
    v_cvt_pk_bf16_f32 v8, -v123, v123
    v_cvt_pk_bf16_f32 v5, -v5, v5
    v_cvt_pk_bf16_f32 v6, -v6, v6
    v_cvt_pk_bf16_f32 v7, -v7, v7
    v_sub_u32_sdwa v4, v4, sext(v8) dst_sel:DWORD dst_unused:UNUSED_PAD src0_sel:DWORD src1_sel:WORD_0
    v_sub_u32_sdwa v9, v9, sext(v5) dst_sel:DWORD dst_unused:UNUSED_PAD src0_sel:DWORD src1_sel:WORD_0
    v_sub_u32_sdwa v14, v14, sext(v6) dst_sel:DWORD dst_unused:UNUSED_PAD src0_sel:DWORD src1_sel:WORD_0
    v_sub_u32_sdwa v20, v20, sext(v7) dst_sel:DWORD dst_unused:UNUSED_PAD src0_sel:DWORD src1_sel:WORD_0
    v_perm_b32 v19, v4, v8, s3
    v_perm_b32 v16, v9, v5, s3
    v_perm_b32 v17, v14, v6, s3
    v_perm_b32 v18, v20, v7, s3
    s_mov_b64 exec, s[46:47]
    buffer_store_dwordx4 v[36:39], v12, s[88:91], 0 offen offset:0 sc0 sc1
    buffer_store_dwordx4 v[40:43], v12, s[88:91], 0 offen offset:256 sc0 sc1
    buffer_store_dwordx4 v[24:27], v12, s[88:91], 0 offen offset:512 sc0 sc1
    buffer_store_dwordx4 v[16:19], v12, s[88:91], 0 offen offset:768 sc0 sc1
    s_mov_b64 exec, -1
    s_mov_b32 s27, 0
    s_cmp_lt_u32 s26, 8
    s_cbranch_scc1 A_W0
    s_waitcnt vmcnt(0)
    v_mov_b32 v126, 2316
    v_mov_b32 v127, 1
    s_mov_b64 exec, 1
    ds_add_u32 v126, v127
    s_mov_b64 exec, -1
    s_cmp_lg_u32 s48, 11
    s_cbranch_scc1 A_W0
    s_setprio 3
    v_mov_b32 v6, 2316
A_DW:
    ds_read_b32 v5, v6
    s_waitcnt lgkmcnt(0)
    v_readfirstlane_b32 s3, v5
    s_nop 0
    s_cmp_ge_u32 s3, 13
    s_cbranch_scc1 A_DW_OK
    s_sleep 1
    s_branch A_DW
A_DW_OK:
    v_lshlrev_b32 v5, 10, v1
    s_lshl_b32 s42, s49, 6
    s_add_u32 s42, s42, s50
    s_lshl_b32 s42, s42, 2
    s_add_u32 s42, s42, 131072
    s_mov_b64 exec, 0xff
    buffer_store_dword v35, v5, s[20:23], s42 offen sc0 sc1
    s_mov_b64 exec, -1
    v_mov_b32 v7, 1564
A_C4W:
    ds_read_b32 v5, v7
    s_waitcnt lgkmcnt(0)
    v_readfirstlane_b32 s3, v5
    s_nop 0
    s_cmp_ge_u32 s3, 1
    s_cbranch_scc1 A_C4W_OK
    s_sleep 2
    s_branch A_C4W
A_C4W_OK:
    v_lshlrev_b32 v7, 3, v1
    s_and_b32 s42, s2, 7
    s_lshl_b32 s42, s42, 10
    s_lshl2_add_u32 s42, s24, s42
    s_add_u32 s42, s42, 139264
    s_mov_b32 s43, 131072
A_SL:
    buffer_load_dwordx2 v[24:25], v7, s[20:23], s42 offen sc0 sc1
    s_waitcnt vmcnt(0)
    v_xor_b32 v24, v24, v35
    v_xor_b32 v25, v25, v35
    v_or_b32 v24, v24, v25
    v_cmp_ne_u32 vcc, 0, v24
    s_cbranch_vccz A_SL_OK
    s_sub_u32 s43, s43, 1
    s_cbranch_scc1 A_SL_OK
    s_sleep 12
    s_branch A_SL
A_SL_OK:
    v_mov_b32 v126, 2352
    v_mov_b32 v127, 1
    s_mov_b64 exec, 1
    ds_add_u32 v126, v127
    s_mov_b64 exec, -1
    v_lshlrev_b32 v7, 2, v1
    s_and_b32 s42, s2, 7
    s_lshl_b32 s42, s42, 10
    s_lshl_b32 s43, s49, 8
    s_add_u32 s42, s42, s43
    s_add_u32 s42, s42, 131072
    s_mov_b32 s43, 131072
A_TL:
    buffer_load_dword v24, v7, s[20:23], s42 offen sc0 sc1
    s_waitcnt vmcnt(0)
    v_xor_b32 v24, v24, v35
    v_cmp_ne_u32 vcc, 0, v24
    s_cbranch_vccz A_TL_OK
    s_sub_u32 s43, s43, 1
    s_cbranch_scc1 A_TL_OK
    s_sleep 12
    s_branch A_TL
A_TL_OK:
    v_mov_b32 v126, 2356
    v_mov_b32 v127, 1
    s_mov_b64 exec, 1
    ds_add_u32 v126, v127
    s_mov_b64 exec, -1
    v_mov_b32 v35, 0
    s_branch A_W0
K_RELOAD:
    s_mov_b32 s95, 0
    v_mov_b32 v62, 0
    v_mov_b32 v63, 0
    v_mov_b32 v35, 0
    s_cmp_ge_u32 s26, 11
    s_cbranch_scc1 RL5
    s_lshl_b32 s3, s26, 3
    v_lshrrev_b32 v5, 3, v1
    v_add_u32 v5, s3, v5
    v_lshlrev_b32 v6, 2, v5
    ds_read_b32 v32, v6 offset:3072
    ds_read_b32 v33, v6 offset:3424
    ds_read_b32 v34, v6 offset:3776
    v_mul_u32_u24 v5, 18816, v5
    v_and_b32 v6, 7, v1
    v_add_u32 v7, s51, v6
    v_mad_u32_u24 v5, v7, 12, v5
    s_cmp_eq_u32 s26, 10
    s_cselect_b32 s3, 0, -1
    s_waitcnt lgkmcnt(0)
    v_and_b32 v34, s3, v34
    v_and_b32 v7, 0xffff, v32
    v_mad_u32_u24 v62, v7, 12, v5
    v_lshrrev_b32 v32, 16, v32
    v_subrev_u32 v32, s51, v32
    v_min_i32 v32, s52, v32
    v_sub_u32 v32, v32, v6
    v_and_b32 v7, 0xffff, v33
    v_mad_u32_u24 v63, v7, 12, v5
    v_lshrrev_b32 v33, 16, v33
    v_subrev_u32 v33, s51, v33
    v_min_i32 v33, s52, v33
    v_sub_u32 v33, v33, v6
    v_and_b32 v7, 0xffff, v34
    v_mad_u32_u24 v35, v7, 12, v5
    v_lshrrev_b32 v34, 16, v34
    v_subrev_u32 v34, s51, v34
    v_min_i32 v34, s52, v34
    v_sub_u32 v34, v34, v6
    v_cmp_lt_i32 s[64:65], 0, v32
    v_cmp_lt_i32 s[66:67], 0, v33
    v_cmp_lt_i32 s[68:69], 0, v34
    v_cmp_lt_i32 s[70:71], 8, v32
    v_cmp_lt_i32 s[72:73], 8, v33
    v_cmp_lt_i32 s[74:75], 8, v34
    v_cmp_lt_i32 s[76:77], 16, v32
    v_cmp_lt_i32 s[78:79], 16, v33
    v_cmp_lt_i32 s[80:81], 16, v34
    v_cmp_lt_i32 s[82:83], 24, v32
    v_cmp_lt_i32 s[84:85], 24, v33
    v_cmp_lt_i32 s[86:87], 24, v34
    v_max3_i32 v7, v32, v33, v34
    s_mov_b32 s95, 6
    v_cmp_lt_i32 vcc, 16, v7
    s_nop 0
    s_cmp_lg_u64 vcc, 0
    s_cselect_b32 s95, 9, s95
    v_cmp_lt_i32 vcc, 24, v7
    s_nop 0
    s_cmp_lg_u64 vcc, 0
    s_cselect_b32 s95, 12, s95
    v_cmp_lt_i32 vcc, 32, v7
    s_nop 0
    s_cmp_lg_u64 vcc, 0
    s_cselect_b32 s95, 15, s95
    v_cmp_lt_i32 vcc, 40, v7
    s_nop 0
    s_cmp_lg_u64 vcc, 0
    s_cselect_b32 s95, 18, s95
    s_cmp_le_u32 s95, 0
    s_cbranch_scc1 FS6
    s_mov_b32 s3, 196608
    s_mov_b64 exec, s[64:65]
    buffer_load_dwordx3 v[64:66], v62, s[20:23], s3 offen offset:0 sc1
    s_mov_b32 s3, 1852416
    s_mov_b64 exec, s[66:67]
    buffer_load_dwordx3 v[68:70], v63, s[20:23], s3 offen offset:0 sc1
    s_mov_b32 s3, 3508224
    s_mov_b64 exec, s[68:69]
    buffer_load_dwordx3 v[72:74], v35, s[20:23], s3 offen offset:0 sc1
    s_mov_b32 s3, 196608
    s_mov_b64 exec, s[70:71]
    buffer_load_dwordx3 v[76:78], v62, s[20:23], s3 offen offset:96 sc1
    s_mov_b32 s3, 1852416
    s_mov_b64 exec, s[72:73]
    buffer_load_dwordx3 v[80:82], v63, s[20:23], s3 offen offset:96 sc1
    s_mov_b32 s3, 3508224
    s_mov_b64 exec, s[74:75]
    buffer_load_dwordx3 v[84:86], v35, s[20:23], s3 offen offset:96 sc1
    s_cmp_le_u32 s95, 6
    s_cbranch_scc1 FS6
    s_mov_b32 s3, 196608
    s_mov_b64 exec, s[76:77]
    buffer_load_dwordx3 v[88:90], v62, s[20:23], s3 offen offset:192 sc1
    s_mov_b32 s3, 1852416
    s_mov_b64 exec, s[78:79]
    buffer_load_dwordx3 v[92:94], v63, s[20:23], s3 offen offset:192 sc1
    s_mov_b32 s3, 3508224
    s_mov_b64 exec, s[80:81]
    buffer_load_dwordx3 v[96:98], v35, s[20:23], s3 offen offset:192 sc1
    s_cmp_le_u32 s95, 9
    s_cbranch_scc1 FS6
    s_mov_b32 s3, 196608
    s_mov_b64 exec, s[82:83]
    buffer_load_dwordx3 v[100:102], v62, s[20:23], s3 offen offset:288 sc1
    s_mov_b32 s3, 1852416
    s_mov_b64 exec, s[84:85]
    buffer_load_dwordx3 v[104:106], v63, s[20:23], s3 offen offset:288 sc1
    s_mov_b32 s3, 3508224
    s_mov_b64 exec, s[86:87]
    buffer_load_dwordx3 v[108:110], v35, s[20:23], s3 offen offset:288 sc1
FS6:
    s_mov_b64 exec, -1
RL5:
A_W0:
    s_cmp_le_u32 s95, 12
    s_cbranch_scc1 FS7
    s_mov_b64 exec, -1
    v_cmp_lt_i32 s[36:37], 32, v32
    v_cmp_lt_i32 s[38:39], 32, v33
    v_cmp_lt_i32 s[40:41], 32, v34
    s_mov_b32 s3, 196608
    s_mov_b64 exec, s[36:37]
    buffer_load_dwordx3 v[112:114], v62, s[20:23], s3 offen offset:384 sc1
    s_mov_b32 s3, 1852416
    s_mov_b64 exec, s[38:39]
    buffer_load_dwordx3 v[116:118], v63, s[20:23], s3 offen offset:384 sc1
    s_mov_b32 s3, 3508224
    s_mov_b64 exec, s[40:41]
    buffer_load_dwordx3 v[120:122], v35, s[20:23], s3 offen offset:384 sc1
    s_cmp_le_u32 s95, 15
    s_cbranch_scc1 FS7
    s_mov_b64 exec, -1
    v_cmp_lt_i32 s[42:43], 40, v32
    v_cmp_lt_i32 s[44:45], 40, v33
    v_cmp_lt_i32 s[46:47], 40, v34
    s_mov_b32 s3, 196608
    s_mov_b64 exec, s[42:43]
    buffer_load_dwordx3 v[124:126], v62, s[20:23], s3 offen offset:480 sc1
    s_mov_b32 s3, 1852416
    s_mov_b64 exec, s[44:45]
    buffer_load_dwordx3 v[36:38], v63, s[20:23], s3 offen offset:480 sc1
    s_mov_b32 s3, 3508224
    s_mov_b64 exec, s[46:47]
    buffer_load_dwordx3 v[40:42], v35, s[20:23], s3 offen offset:480 sc1
FS7:
    s_mov_b64 exec, -1
    v_lshlrev_b32 v21, 4, v1
    v_lshlrev_b32 v22, 3, v1
    v_lshlrev_b32 v23, 2, v1
    v_mov_b32 v29, 1536
    v_mov_b32 v30, 1
    s_waitcnt vmcnt(0)
K_COUNT:
    s_mov_b64 s[88:89], 0
    s_cmp_le_u32 s95, 0
    s_cbranch_scc1 FS8
    s_mov_b64 exec, s[64:65]
    v_and_b32 v44, 0xff, v66
    v_lshlrev_b32 v44, 2, v44
    v_cmp_gt_i32 vcc, 0, v65
    ds_add_rtn_u32 v67, v44, v30 offset:0
    s_or_b64 s[88:89], s[88:89], vcc
    s_mov_b64 exec, s[66:67]
    v_and_b32 v45, 0xff, v70
    v_lshlrev_b32 v45, 2, v45
    v_cmp_gt_i32 vcc, 0, v69
    ds_add_rtn_u32 v71, v45, v30 offset:0
    s_or_b64 s[88:89], s[88:89], vcc
    s_mov_b64 exec, s[68:69]
    v_and_b32 v46, 0xff, v74
    v_lshlrev_b32 v46, 2, v46
    v_cmp_gt_i32 vcc, 0, v73
    ds_add_rtn_u32 v75, v46, v30 offset:0
    s_or_b64 s[88:89], s[88:89], vcc
    s_mov_b64 exec, s[70:71]
    v_and_b32 v47, 0xff, v78
    v_lshlrev_b32 v47, 2, v47
    v_cmp_gt_i32 vcc, 0, v77
    ds_add_rtn_u32 v79, v47, v30 offset:0
    s_or_b64 s[88:89], s[88:89], vcc
    s_mov_b64 exec, s[72:73]
    v_and_b32 v48, 0xff, v82
    v_lshlrev_b32 v48, 2, v48
    v_cmp_gt_i32 vcc, 0, v81
    ds_add_rtn_u32 v83, v48, v30 offset:0
    s_or_b64 s[88:89], s[88:89], vcc
    s_mov_b64 exec, s[74:75]
    v_and_b32 v49, 0xff, v86
    v_lshlrev_b32 v49, 2, v49
    v_cmp_gt_i32 vcc, 0, v85
    ds_add_rtn_u32 v87, v49, v30 offset:0
    s_or_b64 s[88:89], s[88:89], vcc
    s_cmp_le_u32 s95, 6
    s_cbranch_scc1 FS8
    s_mov_b64 exec, s[76:77]
    v_and_b32 v50, 0xff, v90
    v_lshlrev_b32 v50, 2, v50
    v_cmp_gt_i32 vcc, 0, v89
    ds_add_rtn_u32 v91, v50, v30 offset:0
    s_or_b64 s[88:89], s[88:89], vcc
    s_mov_b64 exec, s[78:79]
    v_and_b32 v51, 0xff, v94
    v_lshlrev_b32 v51, 2, v51
    v_cmp_gt_i32 vcc, 0, v93
    ds_add_rtn_u32 v95, v51, v30 offset:0
    s_or_b64 s[88:89], s[88:89], vcc
    s_mov_b64 exec, s[80:81]
    v_and_b32 v52, 0xff, v98
    v_lshlrev_b32 v52, 2, v52
    v_cmp_gt_i32 vcc, 0, v97
    ds_add_rtn_u32 v99, v52, v30 offset:0
    s_or_b64 s[88:89], s[88:89], vcc
    s_cmp_le_u32 s95, 9
    s_cbranch_scc1 FS8
    s_mov_b64 exec, s[82:83]
    v_and_b32 v53, 0xff, v102
    v_lshlrev_b32 v53, 2, v53
    v_cmp_gt_i32 vcc, 0, v101
    ds_add_rtn_u32 v103, v53, v30 offset:0
    s_or_b64 s[88:89], s[88:89], vcc
    s_mov_b64 exec, s[84:85]
    v_and_b32 v54, 0xff, v106
    v_lshlrev_b32 v54, 2, v54
    v_cmp_gt_i32 vcc, 0, v105
    ds_add_rtn_u32 v107, v54, v30 offset:0
    s_or_b64 s[88:89], s[88:89], vcc
    s_mov_b64 exec, s[86:87]
    v_and_b32 v55, 0xff, v110
    v_lshlrev_b32 v55, 2, v55
    v_cmp_gt_i32 vcc, 0, v109
    ds_add_rtn_u32 v111, v55, v30 offset:0
    s_or_b64 s[88:89], s[88:89], vcc
    s_cmp_le_u32 s95, 12
    s_cbranch_scc1 FS8
    s_mov_b64 exec, s[36:37]
    v_and_b32 v56, 0xff, v114
    v_lshlrev_b32 v56, 2, v56
    v_cmp_gt_i32 vcc, 0, v113
    ds_add_rtn_u32 v115, v56, v30 offset:0
    s_or_b64 s[88:89], s[88:89], vcc
    s_mov_b64 exec, s[38:39]
    v_and_b32 v57, 0xff, v118
    v_lshlrev_b32 v57, 2, v57
    v_cmp_gt_i32 vcc, 0, v117
    ds_add_rtn_u32 v119, v57, v30 offset:0
    s_or_b64 s[88:89], s[88:89], vcc
    s_mov_b64 exec, s[40:41]
    v_and_b32 v58, 0xff, v122
    v_lshlrev_b32 v58, 2, v58
    v_cmp_gt_i32 vcc, 0, v121
    ds_add_rtn_u32 v123, v58, v30 offset:0
    s_or_b64 s[88:89], s[88:89], vcc
    s_cmp_le_u32 s95, 15
    s_cbranch_scc1 FS8
    s_mov_b64 exec, s[42:43]
    v_and_b32 v59, 0xff, v126
    v_lshlrev_b32 v59, 2, v59
    v_cmp_gt_i32 vcc, 0, v125
    ds_add_rtn_u32 v127, v59, v30 offset:0
    s_or_b64 s[88:89], s[88:89], vcc
    s_mov_b64 exec, s[44:45]
    v_and_b32 v60, 0xff, v38
    v_lshlrev_b32 v60, 2, v60
    v_cmp_gt_i32 vcc, 0, v37
    ds_add_rtn_u32 v39, v60, v30 offset:0
    s_or_b64 s[88:89], s[88:89], vcc
    s_mov_b64 exec, s[46:47]
    v_and_b32 v61, 0xff, v42
    v_lshlrev_b32 v61, 2, v61
    v_cmp_gt_i32 vcc, 0, v41
    ds_add_rtn_u32 v43, v61, v30 offset:0
    s_or_b64 s[88:89], s[88:89], vcc
FS8:
    s_mov_b64 exec, -1
    s_cmp_eq_u64 s[88:89], 0
    s_cbranch_scc1 K_NOCOLD
    s_mov_b32 s90, 0xffff
    s_cmp_le_u32 s95, 0
    s_cbranch_scc1 FS9
    s_mov_b64 exec, s[64:65]
    v_cmp_gt_i32 vcc, 0, v65
    s_cbranch_vccz K_CS0
    s_mov_b64 exec, vcc
    ds_add_rtn_u32 v28, v29, v30 offset:16
    v_bfe_u32 v31, v65, 16, 15
    s_waitcnt lgkmcnt(0)
    v_and_b32 v28, 0xff, v28
    v_lshlrev_b32 v5, 2, v28
    ds_write_b32 v5, v31 offset:4096
    v_lshlrev_b32 v28, 21, v28
    v_add_u32 v28, 0x41000000, v28
    v_bfi_b32 v65, s90, v65, v28
K_CS0:
    s_mov_b64 exec, s[66:67]
    v_cmp_gt_i32 vcc, 0, v69
    s_cbranch_vccz K_CS1
    s_mov_b64 exec, vcc
    ds_add_rtn_u32 v28, v29, v30 offset:16
    v_bfe_u32 v31, v69, 16, 15
    s_waitcnt lgkmcnt(0)
    v_and_b32 v28, 0xff, v28
    v_lshlrev_b32 v5, 2, v28
    ds_write_b32 v5, v31 offset:4096
    v_lshlrev_b32 v28, 21, v28
    v_add_u32 v28, 0x41000000, v28
    v_bfi_b32 v69, s90, v69, v28
K_CS1:
    s_mov_b64 exec, s[68:69]
    v_cmp_gt_i32 vcc, 0, v73
    s_cbranch_vccz K_CS2
    s_mov_b64 exec, vcc
    ds_add_rtn_u32 v28, v29, v30 offset:16
    v_bfe_u32 v31, v73, 16, 15
    s_waitcnt lgkmcnt(0)
    v_and_b32 v28, 0xff, v28
    v_lshlrev_b32 v5, 2, v28
    ds_write_b32 v5, v31 offset:4096
    v_lshlrev_b32 v28, 21, v28
    v_add_u32 v28, 0x41000000, v28
    v_bfi_b32 v73, s90, v73, v28
K_CS2:
    s_mov_b64 exec, s[70:71]
    v_cmp_gt_i32 vcc, 0, v77
    s_cbranch_vccz K_CS3
    s_mov_b64 exec, vcc
    ds_add_rtn_u32 v28, v29, v30 offset:16
    v_bfe_u32 v31, v77, 16, 15
    s_waitcnt lgkmcnt(0)
    v_and_b32 v28, 0xff, v28
    v_lshlrev_b32 v5, 2, v28
    ds_write_b32 v5, v31 offset:4096
    v_lshlrev_b32 v28, 21, v28
    v_add_u32 v28, 0x41000000, v28
    v_bfi_b32 v77, s90, v77, v28
K_CS3:
    s_mov_b64 exec, s[72:73]
    v_cmp_gt_i32 vcc, 0, v81
    s_cbranch_vccz K_CS4
    s_mov_b64 exec, vcc
    ds_add_rtn_u32 v28, v29, v30 offset:16
    v_bfe_u32 v31, v81, 16, 15
    s_waitcnt lgkmcnt(0)
    v_and_b32 v28, 0xff, v28
    v_lshlrev_b32 v5, 2, v28
    ds_write_b32 v5, v31 offset:4096
    v_lshlrev_b32 v28, 21, v28
    v_add_u32 v28, 0x41000000, v28
    v_bfi_b32 v81, s90, v81, v28
K_CS4:
    s_mov_b64 exec, s[74:75]
    v_cmp_gt_i32 vcc, 0, v85
    s_cbranch_vccz K_CS5
    s_mov_b64 exec, vcc
    ds_add_rtn_u32 v28, v29, v30 offset:16
    v_bfe_u32 v31, v85, 16, 15
    s_waitcnt lgkmcnt(0)
    v_and_b32 v28, 0xff, v28
    v_lshlrev_b32 v5, 2, v28
    ds_write_b32 v5, v31 offset:4096
    v_lshlrev_b32 v28, 21, v28
    v_add_u32 v28, 0x41000000, v28
    v_bfi_b32 v85, s90, v85, v28
K_CS5:
    s_cmp_le_u32 s95, 6
    s_cbranch_scc1 FS9
    s_mov_b64 exec, s[76:77]
    v_cmp_gt_i32 vcc, 0, v89
    s_cbranch_vccz K_CS6
    s_mov_b64 exec, vcc
    ds_add_rtn_u32 v28, v29, v30 offset:16
    v_bfe_u32 v31, v89, 16, 15
    s_waitcnt lgkmcnt(0)
    v_and_b32 v28, 0xff, v28
    v_lshlrev_b32 v5, 2, v28
    ds_write_b32 v5, v31 offset:4096
    v_lshlrev_b32 v28, 21, v28
    v_add_u32 v28, 0x41000000, v28
    v_bfi_b32 v89, s90, v89, v28
K_CS6:
    s_mov_b64 exec, s[78:79]
    v_cmp_gt_i32 vcc, 0, v93
    s_cbranch_vccz K_CS7
    s_mov_b64 exec, vcc
    ds_add_rtn_u32 v28, v29, v30 offset:16
    v_bfe_u32 v31, v93, 16, 15
    s_waitcnt lgkmcnt(0)
    v_and_b32 v28, 0xff, v28
    v_lshlrev_b32 v5, 2, v28
    ds_write_b32 v5, v31 offset:4096
    v_lshlrev_b32 v28, 21, v28
    v_add_u32 v28, 0x41000000, v28
    v_bfi_b32 v93, s90, v93, v28
K_CS7:
    s_mov_b64 exec, s[80:81]
    v_cmp_gt_i32 vcc, 0, v97
    s_cbranch_vccz K_CS8
    s_mov_b64 exec, vcc
    ds_add_rtn_u32 v28, v29, v30 offset:16
    v_bfe_u32 v31, v97, 16, 15
    s_waitcnt lgkmcnt(0)
    v_and_b32 v28, 0xff, v28
    v_lshlrev_b32 v5, 2, v28
    ds_write_b32 v5, v31 offset:4096
    v_lshlrev_b32 v28, 21, v28
    v_add_u32 v28, 0x41000000, v28
    v_bfi_b32 v97, s90, v97, v28
K_CS8:
    s_cmp_le_u32 s95, 9
    s_cbranch_scc1 FS9
    s_mov_b64 exec, s[82:83]
    v_cmp_gt_i32 vcc, 0, v101
    s_cbranch_vccz K_CS9
    s_mov_b64 exec, vcc
    ds_add_rtn_u32 v28, v29, v30 offset:16
    v_bfe_u32 v31, v101, 16, 15
    s_waitcnt lgkmcnt(0)
    v_and_b32 v28, 0xff, v28
    v_lshlrev_b32 v5, 2, v28
    ds_write_b32 v5, v31 offset:4096
    v_lshlrev_b32 v28, 21, v28
    v_add_u32 v28, 0x41000000, v28
    v_bfi_b32 v101, s90, v101, v28
K_CS9:
    s_mov_b64 exec, s[84:85]
    v_cmp_gt_i32 vcc, 0, v105
    s_cbranch_vccz K_CS10
    s_mov_b64 exec, vcc
    ds_add_rtn_u32 v28, v29, v30 offset:16
    v_bfe_u32 v31, v105, 16, 15
    s_waitcnt lgkmcnt(0)
    v_and_b32 v28, 0xff, v28
    v_lshlrev_b32 v5, 2, v28
    ds_write_b32 v5, v31 offset:4096
    v_lshlrev_b32 v28, 21, v28
    v_add_u32 v28, 0x41000000, v28
    v_bfi_b32 v105, s90, v105, v28
K_CS10:
    s_mov_b64 exec, s[86:87]
    v_cmp_gt_i32 vcc, 0, v109
    s_cbranch_vccz K_CS11
    s_mov_b64 exec, vcc
    ds_add_rtn_u32 v28, v29, v30 offset:16
    v_bfe_u32 v31, v109, 16, 15
    s_waitcnt lgkmcnt(0)
    v_and_b32 v28, 0xff, v28
    v_lshlrev_b32 v5, 2, v28
    ds_write_b32 v5, v31 offset:4096
    v_lshlrev_b32 v28, 21, v28
    v_add_u32 v28, 0x41000000, v28
    v_bfi_b32 v109, s90, v109, v28
K_CS11:
    s_cmp_le_u32 s95, 12
    s_cbranch_scc1 FS9
    s_mov_b64 exec, s[36:37]
    v_cmp_gt_i32 vcc, 0, v113
    s_cbranch_vccz K_CS12
    s_mov_b64 exec, vcc
    ds_add_rtn_u32 v28, v29, v30 offset:16
    v_bfe_u32 v31, v113, 16, 15
    s_waitcnt lgkmcnt(0)
    v_and_b32 v28, 0xff, v28
    v_lshlrev_b32 v5, 2, v28
    ds_write_b32 v5, v31 offset:4096
    v_lshlrev_b32 v28, 21, v28
    v_add_u32 v28, 0x41000000, v28
    v_bfi_b32 v113, s90, v113, v28
K_CS12:
    s_mov_b64 exec, s[38:39]
    v_cmp_gt_i32 vcc, 0, v117
    s_cbranch_vccz K_CS13
    s_mov_b64 exec, vcc
    ds_add_rtn_u32 v28, v29, v30 offset:16
    v_bfe_u32 v31, v117, 16, 15
    s_waitcnt lgkmcnt(0)
    v_and_b32 v28, 0xff, v28
    v_lshlrev_b32 v5, 2, v28
    ds_write_b32 v5, v31 offset:4096
    v_lshlrev_b32 v28, 21, v28
    v_add_u32 v28, 0x41000000, v28
    v_bfi_b32 v117, s90, v117, v28
K_CS13:
    s_mov_b64 exec, s[40:41]
    v_cmp_gt_i32 vcc, 0, v121
    s_cbranch_vccz K_CS14
    s_mov_b64 exec, vcc
    ds_add_rtn_u32 v28, v29, v30 offset:16
    v_bfe_u32 v31, v121, 16, 15
    s_waitcnt lgkmcnt(0)
    v_and_b32 v28, 0xff, v28
    v_lshlrev_b32 v5, 2, v28
    ds_write_b32 v5, v31 offset:4096
    v_lshlrev_b32 v28, 21, v28
    v_add_u32 v28, 0x41000000, v28
    v_bfi_b32 v121, s90, v121, v28
K_CS14:
    s_cmp_le_u32 s95, 15
    s_cbranch_scc1 FS9
    s_mov_b64 exec, s[42:43]
    v_cmp_gt_i32 vcc, 0, v125
    s_cbranch_vccz K_CS15
    s_mov_b64 exec, vcc
    ds_add_rtn_u32 v28, v29, v30 offset:16
    v_bfe_u32 v31, v125, 16, 15
    s_waitcnt lgkmcnt(0)
    v_and_b32 v28, 0xff, v28
    v_lshlrev_b32 v5, 2, v28
    ds_write_b32 v5, v31 offset:4096
    v_lshlrev_b32 v28, 21, v28
    v_add_u32 v28, 0x41000000, v28
    v_bfi_b32 v125, s90, v125, v28
K_CS15:
    s_mov_b64 exec, s[44:45]
    v_cmp_gt_i32 vcc, 0, v37
    s_cbranch_vccz K_CS16
    s_mov_b64 exec, vcc
    ds_add_rtn_u32 v28, v29, v30 offset:16
    v_bfe_u32 v31, v37, 16, 15
    s_waitcnt lgkmcnt(0)
    v_and_b32 v28, 0xff, v28
    v_lshlrev_b32 v5, 2, v28
    ds_write_b32 v5, v31 offset:4096
    v_lshlrev_b32 v28, 21, v28
    v_add_u32 v28, 0x41000000, v28
    v_bfi_b32 v37, s90, v37, v28
K_CS16:
    s_mov_b64 exec, s[46:47]
    v_cmp_gt_i32 vcc, 0, v41
    s_cbranch_vccz K_CS17
    s_mov_b64 exec, vcc
    ds_add_rtn_u32 v28, v29, v30 offset:16
    v_bfe_u32 v31, v41, 16, 15
    s_waitcnt lgkmcnt(0)
    v_and_b32 v28, 0xff, v28
    v_lshlrev_b32 v5, 2, v28
    ds_write_b32 v5, v31 offset:4096
    v_lshlrev_b32 v28, 21, v28
    v_add_u32 v28, 0x41000000, v28
    v_bfi_b32 v41, s90, v41, v28
K_CS17:
FS9:
    s_mov_b64 exec, -1
K_NOCOLD:
    s_cmp_ge_u32 s26, 11
    s_cbranch_scc1 K_AR2
    s_mov_b64 exec, 1
    ds_add_u32 v29, v30 offset:20
    s_mov_b64 exec, -1
K_AR2:
    s_cmp_ge_u32 s26, 8
    s_cbranch_scc1 K_AR8
    s_mov_b64 exec, 1
    ds_add_u32 v29, v30 offset:844
    s_mov_b64 exec, -1
K_AR8:
    s_cmp_lg_u32 s27, 1
    s_cbranch_scc1 K_NS1
    v_mov_b32 v31, 2376
K_IW:
    ds_read_b32 v28, v31
    s_waitcnt lgkmcnt(0)
    v_readfirstlane_b32 s3, v28
    s_nop 0
    s_cmp_ge_u32 s3, 11
    s_cbranch_scc1 K_IW_OK
    s_sleep 1
    s_branch K_IW
K_IW_OK:
    v_mov_b32 v11, 2348
K_VW:
    ds_read_b32 v10, v11
    s_waitcnt lgkmcnt(0)
    v_readfirstlane_b32 s3, v10
    s_nop 0
    s_cmp_ge_u32 s3, 2
    s_cbranch_scc1 K_VW_OK
    s_sleep 2
    s_branch K_VW
K_VW_OK:
    ds_read_b32 v36, v13 offset:0
    ds_read_b32 v37, v13 offset:64
    ds_read_b32 v38, v13 offset:128
    ds_read_b32 v40, v13 offset:256
    ds_read_b32 v41, v13 offset:320
    ds_read_b32 v42, v13 offset:384
    ds_read_b32 v24, v13 offset:512
    ds_read_b32 v25, v13 offset:576
    ds_read_b32 v26, v13 offset:640
    ds_read_b32 v16, v13 offset:768
    ds_read_b32 v17, v13 offset:832
    ds_read_b32 v18, v13 offset:896
    s_mov_b32 s88, s32
    s_mov_b32 s89, s33
    s_mov_b32 s90, 0xf50000
    s_mov_b32 s91, 0x20000
    s_mov_b32 s3, 0x07060302
    v_mov_b32 v15, 0x0d800000
    s_waitcnt lgkmcnt(0)
    v_cvt_pk_bf16_f32 v10, 0, v112
    v_cvt_pk_bf16_f32 v11, 0, v116
    v_add_f32 v4, v124, v15
    v_lshlrev_b32 v5, 16, v36
    v_lshlrev_b32 v6, 16, v37
    v_lshlrev_b32 v7, 16, v38
    v_and_b32 v9, 0xffff0000, v36
    v_and_b32 v14, 0xffff0000, v37
    v_and_b32 v20, 0xffff0000, v38
    v_cvt_pk_bf16_f32 v4, 0, v4
    v_mul_f32 v5, v5, v10
    v_mul_f32 v6, v6, v10
    v_mul_f32 v7, v7, v10
    v_fma_f32 v9, v9, v11, v15
    v_fma_f32 v14, v14, v11, v15
    v_fma_f32 v20, v20, v11, v15
    v_cvt_pk_bf16_f32 v8, -v120, v120
    v_cvt_pk_bf16_f32 v5, -v5, v5
    v_cvt_pk_bf16_f32 v6, -v6, v6
    v_cvt_pk_bf16_f32 v7, -v7, v7
    v_sub_u32_sdwa v4, v4, sext(v8) dst_sel:DWORD dst_unused:UNUSED_PAD src0_sel:DWORD src1_sel:WORD_0
    v_sub_u32_sdwa v9, v9, sext(v5) dst_sel:DWORD dst_unused:UNUSED_PAD src0_sel:DWORD src1_sel:WORD_0
    v_sub_u32_sdwa v14, v14, sext(v6) dst_sel:DWORD dst_unused:UNUSED_PAD src0_sel:DWORD src1_sel:WORD_0
    v_sub_u32_sdwa v20, v20, sext(v7) dst_sel:DWORD dst_unused:UNUSED_PAD src0_sel:DWORD src1_sel:WORD_0
    v_perm_b32 v39, v4, v8, s3
    v_perm_b32 v36, v9, v5, s3
    v_perm_b32 v37, v14, v6, s3
    v_perm_b32 v38, v20, v7, s3
    v_cvt_pk_bf16_f32 v10, 0, v113
    v_cvt_pk_bf16_f32 v11, 0, v117
    v_add_f32 v4, v125, v15
    v_lshlrev_b32 v5, 16, v40
    v_lshlrev_b32 v6, 16, v41
    v_lshlrev_b32 v7, 16, v42
    v_and_b32 v9, 0xffff0000, v40
    v_and_b32 v14, 0xffff0000, v41
    v_and_b32 v20, 0xffff0000, v42
    v_cvt_pk_bf16_f32 v4, 0, v4
    v_mul_f32 v5, v5, v10
    v_mul_f32 v6, v6, v10
    v_mul_f32 v7, v7, v10
    v_fma_f32 v9, v9, v11, v15
    v_fma_f32 v14, v14, v11, v15
    v_fma_f32 v20, v20, v11, v15
    v_cvt_pk_bf16_f32 v8, -v121, v121
    v_cvt_pk_bf16_f32 v5, -v5, v5
    v_cvt_pk_bf16_f32 v6, -v6, v6
    v_cvt_pk_bf16_f32 v7, -v7, v7
    v_sub_u32_sdwa v4, v4, sext(v8) dst_sel:DWORD dst_unused:UNUSED_PAD src0_sel:DWORD src1_sel:WORD_0
    v_sub_u32_sdwa v9, v9, sext(v5) dst_sel:DWORD dst_unused:UNUSED_PAD src0_sel:DWORD src1_sel:WORD_0
    v_sub_u32_sdwa v14, v14, sext(v6) dst_sel:DWORD dst_unused:UNUSED_PAD src0_sel:DWORD src1_sel:WORD_0
    v_sub_u32_sdwa v20, v20, sext(v7) dst_sel:DWORD dst_unused:UNUSED_PAD src0_sel:DWORD src1_sel:WORD_0
    v_perm_b32 v43, v4, v8, s3
    v_perm_b32 v40, v9, v5, s3
    v_perm_b32 v41, v14, v6, s3
    v_perm_b32 v42, v20, v7, s3
    v_cvt_pk_bf16_f32 v10, 0, v114
    v_cvt_pk_bf16_f32 v11, 0, v118
    v_add_f32 v4, v126, v15
    v_lshlrev_b32 v5, 16, v24
    v_lshlrev_b32 v6, 16, v25
    v_lshlrev_b32 v7, 16, v26
    v_and_b32 v9, 0xffff0000, v24
    v_and_b32 v14, 0xffff0000, v25
    v_and_b32 v20, 0xffff0000, v26
    v_cvt_pk_bf16_f32 v4, 0, v4
    v_mul_f32 v5, v5, v10
    v_mul_f32 v6, v6, v10
    v_mul_f32 v7, v7, v10
    v_fma_f32 v9, v9, v11, v15
    v_fma_f32 v14, v14, v11, v15
    v_fma_f32 v20, v20, v11, v15
    v_cvt_pk_bf16_f32 v8, -v122, v122
    v_cvt_pk_bf16_f32 v5, -v5, v5
    v_cvt_pk_bf16_f32 v6, -v6, v6
    v_cvt_pk_bf16_f32 v7, -v7, v7
    v_sub_u32_sdwa v4, v4, sext(v8) dst_sel:DWORD dst_unused:UNUSED_PAD src0_sel:DWORD src1_sel:WORD_0
    v_sub_u32_sdwa v9, v9, sext(v5) dst_sel:DWORD dst_unused:UNUSED_PAD src0_sel:DWORD src1_sel:WORD_0
    v_sub_u32_sdwa v14, v14, sext(v6) dst_sel:DWORD dst_unused:UNUSED_PAD src0_sel:DWORD src1_sel:WORD_0
    v_sub_u32_sdwa v20, v20, sext(v7) dst_sel:DWORD dst_unused:UNUSED_PAD src0_sel:DWORD src1_sel:WORD_0
    v_perm_b32 v27, v4, v8, s3
    v_perm_b32 v24, v9, v5, s3
    v_perm_b32 v25, v14, v6, s3
    v_perm_b32 v26, v20, v7, s3
    v_cvt_pk_bf16_f32 v10, 0, v115
    v_cvt_pk_bf16_f32 v11, 0, v119
    v_add_f32 v4, v127, v15
    v_lshlrev_b32 v5, 16, v16
    v_lshlrev_b32 v6, 16, v17
    v_lshlrev_b32 v7, 16, v18
    v_and_b32 v9, 0xffff0000, v16
    v_and_b32 v14, 0xffff0000, v17
    v_and_b32 v20, 0xffff0000, v18
    v_cvt_pk_bf16_f32 v4, 0, v4
    v_mul_f32 v5, v5, v10
    v_mul_f32 v6, v6, v10
    v_mul_f32 v7, v7, v10
    v_fma_f32 v9, v9, v11, v15
    v_fma_f32 v14, v14, v11, v15
    v_fma_f32 v20, v20, v11, v15
    v_cvt_pk_bf16_f32 v8, -v123, v123
    v_cvt_pk_bf16_f32 v5, -v5, v5
    v_cvt_pk_bf16_f32 v6, -v6, v6
    v_cvt_pk_bf16_f32 v7, -v7, v7
    v_sub_u32_sdwa v4, v4, sext(v8) dst_sel:DWORD dst_unused:UNUSED_PAD src0_sel:DWORD src1_sel:WORD_0
    v_sub_u32_sdwa v9, v9, sext(v5) dst_sel:DWORD dst_unused:UNUSED_PAD src0_sel:DWORD src1_sel:WORD_0
    v_sub_u32_sdwa v14, v14, sext(v6) dst_sel:DWORD dst_unused:UNUSED_PAD src0_sel:DWORD src1_sel:WORD_0
    v_sub_u32_sdwa v20, v20, sext(v7) dst_sel:DWORD dst_unused:UNUSED_PAD src0_sel:DWORD src1_sel:WORD_0
    v_perm_b32 v19, v4, v8, s3
    v_perm_b32 v16, v9, v5, s3
    v_perm_b32 v17, v14, v6, s3
    v_perm_b32 v18, v20, v7, s3
    s_mov_b64 exec, s[46:47]
    buffer_store_dwordx4 v[36:39], v12, s[88:91], 0 offen offset:0 sc0 sc1
    buffer_store_dwordx4 v[40:43], v12, s[88:91], 0 offen offset:256 sc0 sc1
    buffer_store_dwordx4 v[24:27], v12, s[88:91], 0 offen offset:512 sc0 sc1
    buffer_store_dwordx4 v[16:19], v12, s[88:91], 0 offen offset:768 sc0 sc1
    s_mov_b64 exec, -1
    s_mov_b32 s27, 0
K_NS1:
    v_mov_b32 v31, 1556
K_B2:
    ds_read_b32 v28, v31
    s_waitcnt lgkmcnt(0)
    v_readfirstlane_b32 s3, v28
    s_nop 0
    s_cmp_ge_u32 s3, 11
    s_cbranch_scc1 K_B2_OK
    s_sleep 1
    s_branch K_B2
K_B2_OK:
    ds_read_b32 v28, v29 offset:776
    ds_read_b32 v31, v29 offset:16
    s_cmp_lg_u32 s48, 15
    s_cbranch_scc1 K_NOTW0
    s_setprio 3
    ds_read_b128 v[72:75], v21 offset:0
K_NOTW0:
    s_waitcnt lgkmcnt(0)
    v_readfirstlane_b32 s93, v28
    v_readfirstlane_b32 s94, v31
    s_add_u32 s90, s51, s52
    s_add_u32 s90, s90, 1
    s_cmp_ge_u32 s90, s93
    s_cselect_b32 s55, 1, 0
    s_xor_b32 s53, s55, 1
    s_or_b32 s53, s53, s51
    s_cmp_eq_u32 s48, 15
    s_cbranch_scc1 K_S3
    s_cmp_lt_u32 s48, 13
    s_cbranch_scc1 K_S3DONE
    v_subrev_u32 v7, 832, v0
    v_lshlrev_b32 v6, 4, v7
    v_mov_b32 v24, 0x40000000
    v_mov_b32 v25, 0x40000000
    v_mov_b32 v26, 0x40000000
    v_mov_b32 v27, 0x40000000
    v_mov_b32 v8, 0
    v_mov_b32 v9, 0x40000000
    v_mov_b32 v10, 0
    v_mov_b32 v11, 0x40000000
    v_add_u32 v5, 54016, v6
    v_mov_b32 v12, 1536
    ds_read_b32 v12, v12 offset:16
    v_mov_b32 v14, 2368
K_WD:
    ds_read_b32 v13, v14
    s_waitcnt lgkmcnt(0)
    v_readfirstlane_b32 s3, v13
    s_nop 0
    s_cmp_ge_u32 s3, 13
    s_cbranch_scc1 K_WD_OK
    s_sleep 1
    s_branch K_WD
K_WD_OK:
    ds_write_b128 v5, v[8:11] offset:0
    ds_write_b128 v5, v[8:11] offset:2048
    ds_write_b128 v5, v[8:11] offset:4096
    ds_write_b128 v5, v[8:11] offset:6144
    ds_write_b128 v5, v[8:11] offset:8192
    ds_write_b128 v5, v[8:11] offset:10240
    ds_write_b128 v5, v[8:11] offset:12288
    ds_write_b128 v5, v[8:11] offset:14336
    ds_write_b128 v5, v[8:11] offset:16384
    ds_write_b128 v5, v[8:11] offset:18432
    ds_write_b128 v5, v[8:11] offset:20480
    ds_write_b128 v5, v[8:11] offset:22528
    ds_write_b128 v5, v[8:11] offset:24576
    ds_write_b128 v5, v[8:11] offset:26624
    ds_write_b128 v5, v[8:11] offset:28672
    ds_write_b128 v5, v[8:11] offset:30720
    ds_write_b128 v5, v[8:11] offset:32768
    ds_write_b128 v5, v[8:11] offset:34816
    ds_write_b128 v5, v[8:11] offset:36864
    ds_write_b128 v5, v[8:11] offset:38912
    ds_write_b128 v5, v[8:11] offset:40960
    ds_write_b128 v5, v[8:11] offset:43008
    ds_write_b128 v6, v[24:27] offset:31488
    ds_write_b128 v6, v[24:27] offset:33536
    ds_write_b128 v6, v[24:27] offset:35584
    ds_write_b128 v6, v[24:27] offset:37632
    ds_write_b128 v6, v[24:27] offset:39680
    ds_write_b128 v6, v[24:27] offset:41728
    ds_write_b128 v6, v[24:27] offset:43776
    ds_write_b128 v6, v[24:27] offset:45824
    ds_write_b128 v6, v[24:27] offset:47872
    ds_write_b128 v6, v[24:27] offset:49920
    ds_write_b128 v6, v[24:27] offset:51968
    s_mov_b64 exec, 1
    ds_add_u32 v29, v30 offset:24
    s_mov_b64 exec, -1
    v_and_b32 v5, 3, v1
    v_lshlrev_b32 v5, 4, v5
    ds_read_b128 v[8:11], v5 offset:2816
    s_waitcnt lgkmcnt(0)
    v_readfirstlane_b32 s88, v12
    s_nop 0
    s_min_u32 s88, s88, 256
    s_sub_u32 s89, s48, 13
    s_lshl_b32 s89, s89, 4
K_CL:
    s_cmp_ge_u32 s89, s88
    s_cbranch_scc1 K_CD
    v_and_b32 v5, -4, v1
    s_lshl_b32 s3, s89, 2
    v_add_u32 v5, s3, v5
    ds_read_b32 v5, v5 offset:4096
    s_lshl_b32 s3, s89, 5
    v_lshl_add_u32 v6, v1, 3, s3
    s_waitcnt lgkmcnt(0)
    v_add_u32 v5, 14528, v5
    v_lshlrev_b32 v5, 16, v5
    v_rcp_f32 v12, v5
    v_mul_f32 v13, 0x40490fdb, v5
    v_mul_f32 v14, v8, v5
    v_mul_f32 v15, v9, v5
    v_mul_f32 v16, v10, v5
    v_mul_f32 v17, v11, v5
    v_cvt_pk_bf16_f32 v13, 0, v13
    v_cvt_pk_bf16_f32 v14, 0, v14
    v_cvt_pk_bf16_f32 v15, 0, v15
    v_cvt_pk_bf16_f32 v16, 0, v16
    v_cvt_pk_bf16_f32 v17, 0, v17
    v_mul_f32 v13, 0x3e4ccccd, v13
    v_mul_f32 v14, 0.15915494, v14
    v_mul_f32 v15, 0.15915494, v15
    v_mul_f32 v16, 0.15915494, v16
    v_mul_f32 v17, 0.15915494, v17
    v_cvt_pk_bf16_f32 v13, 0, v13
    v_rndne_f32 v18, v14
    v_sub_f32 v14, v14, v18
    v_rndne_f32 v18, v15
    v_sub_f32 v15, v15, v18
    v_rndne_f32 v18, v16
    v_sub_f32 v16, v16, v18
    v_rndne_f32 v18, v17
    v_sub_f32 v17, v17, v18
    v_mul_f32 v13, 0.15915494, v13
    v_cos_f32 v13, v13
    v_sin_f32 v14, v14
    v_sin_f32 v15, v15
    v_sin_f32 v16, v16
    v_sin_f32 v17, v17
    v_cvt_pk_bf16_f32 v13, 0, v13
    v_cvt_pk_bf16_f32 v14, 0, v14
    v_cvt_pk_bf16_f32 v15, 0, v15
    v_cvt_pk_bf16_f32 v16, 0, v16
    v_cvt_pk_bf16_f32 v17, 0, v17
    v_add_f32 v13, 1.0, v13
    v_mul_f32 v14, v14, v12
    v_mul_f32 v15, v15, v12
    v_mul_f32 v16, v16, v12
    v_mul_f32 v17, v17, v12
    v_cvt_pk_bf16_f32 v13, 0, v13
    v_cvt_pk_bf16_f32 v14, 0, v14
    v_cvt_pk_bf16_f32 v15, 0, v15
    v_cvt_pk_bf16_f32 v16, 0, v16
    v_cvt_pk_bf16_f32 v17, 0, v17
    v_mul_f32 v13, 0.5, v13
    v_cvt_pk_bf16_f32 v13, 0, v13
    v_mul_f32 v14, v14, v13
    v_mul_f32 v15, v15, v13
    v_mul_f32 v16, v16, v13
    v_mul_f32 v17, v17, v13
    v_cvt_pk_bf16_f32 v62, v14, v15
    v_cvt_pk_bf16_f32 v63, v16, v17
    ds_write_b64 v6, v[62:63] offset:23296
    s_add_u32 s89, s89, 32
    s_branch K_CL
K_CD:
    s_branch K_S3DONE
K_S3:
    s_mov_b32 s90, -1
    s_mov_b32 s91, 0x1ffff
    v_min_u32 v84, 63, v72
    v_sub_u32 v84, 63, v84
    v_lshlrev_b32 v84, 2, v84
    v_min_u32 v85, 63, v73
    v_sub_u32 v85, 63, v85
    v_lshlrev_b32 v85, 2, v85
    v_min_u32 v86, 63, v74
    v_sub_u32 v86, 63, v86
    v_lshlrev_b32 v86, 2, v86
    v_min_u32 v87, 63, v75
    v_sub_u32 v87, 63, v87
    v_lshlrev_b32 v87, 2, v87
    s_mov_b64 exec, s[90:91]
    ds_add_rtn_u32 v96, v84, v30 offset:1024
    ds_add_rtn_u32 v97, v85, v30 offset:1024
    ds_add_rtn_u32 v98, v86, v30 offset:1024
    ds_add_rtn_u32 v99, v87, v30 offset:1024
    s_mov_b64 exec, -1
    ds_read_b32 v17, v23 offset:1024
    v_mov_b32 v19, 0x100000
    ds_write_b32 v23, v19 offset:5888
    s_waitcnt lgkmcnt(1)
    v_mov_b32 v16, v17
    s_nop 1
    v_add_u32_dpp v16, v16, v16 row_shr:1 row_mask:0xf bank_mask:0xf bound_ctrl:0
    s_nop 1
    v_add_u32_dpp v16, v16, v16 row_shr:2 row_mask:0xf bank_mask:0xf bound_ctrl:0
    s_nop 1
    v_add_u32_dpp v16, v16, v16 row_shr:4 row_mask:0xf bank_mask:0xf bound_ctrl:0
    s_nop 1
    v_add_u32_dpp v16, v16, v16 row_shr:8 row_mask:0xf bank_mask:0xf bound_ctrl:0
    s_nop 1
    v_add_u32_dpp v16, v16, v16 row_bcast:15 row_mask:0xa bank_mask:0xf
    s_nop 1
    v_add_u32_dpp v16, v16, v16 row_bcast:31 row_mask:0xc bank_mask:0xf
    v_sub_u32 v16, v16, v17
    ds_bpermute_b32 v108, v84, v16
    ds_bpermute_b32 v109, v85, v16
    ds_bpermute_b32 v110, v86, v16
    ds_bpermute_b32 v111, v87, v16
    s_waitcnt lgkmcnt(0)
    v_add_u32 v108, v108, v96
    v_add_u32 v96, 0, v23
    v_add_u32 v109, v109, v97
    v_add_u32 v97, 1, v23
    v_add_u32 v110, v110, v98
    v_add_u32 v98, 2, v23
    v_add_u32 v111, v111, v99
    v_add_u32 v99, 3, v23
    s_cmp_eq_u32 s53, 0
    s_cbranch_scc1 K_SORTED
    v_mov_b32 v108, v96
    v_mov_b32 v109, v97
    v_mov_b32 v110, v98
    v_mov_b32 v111, v99
K_SORTED:
    v_and_b32 v5, -4, v108
    v_and_b32 v6, -4, v109
    v_and_b32 v7, -4, v110
    v_and_b32 v8, -4, v111
    s_mov_b64 exec, s[90:91]
    ds_max_u32 v5, v72 offset:1280
    ds_max_u32 v6, v73 offset:1280
    ds_max_u32 v7, v74 offset:1280
    ds_max_u32 v8, v75 offset:1280
    s_mov_b64 exec, -1
    ds_read_b32 v11, v23 offset:1280
    v_lshlrev_b32 v84, 2, v108
    v_lshlrev_b32 v85, 2, v109
    v_lshlrev_b32 v86, 2, v110
    v_lshlrev_b32 v87, 2, v111
    s_mov_b64 exec, s[90:91]
    ds_write_b32 v84, v96 offset:5120
    ds_write_b32 v85, v97 offset:5120
    ds_write_b32 v86, v98 offset:5120
    ds_write_b32 v87, v99 offset:5120
    s_mov_b64 exec, -1
    s_waitcnt lgkmcnt(4)
    v_max_u32_dpp v17, v11, v11 quad_perm:[1,0,3,2] row_mask:0xf bank_mask:0xf
    v_add_u32 v17, 3, v17
    v_lshrrev_b32 v17, 2, v17
    v_mov_b32 v16, v17
    s_nop 1
    v_add_u32_dpp v16, v16, v16 row_shr:1 row_mask:0xf bank_mask:0xf bound_ctrl:0
    s_nop 1
    v_add_u32_dpp v16, v16, v16 row_shr:2 row_mask:0xf bank_mask:0xf bound_ctrl:0
    s_nop 1
    v_add_u32_dpp v16, v16, v16 row_shr:4 row_mask:0xf bank_mask:0xf bound_ctrl:0
    s_nop 1
    v_add_u32_dpp v16, v16, v16 row_shr:8 row_mask:0xf bank_mask:0xf bound_ctrl:0
    s_nop 1
    v_add_u32_dpp v16, v16, v16 row_bcast:15 row_mask:0xa bank_mask:0xf
    s_nop 1
    v_add_u32_dpp v16, v16, v16 row_bcast:31 row_mask:0xc bank_mask:0xf
    v_sub_u32 v10, v16, v17
    ds_bpermute_b32 v72, v5, v10
    ds_bpermute_b32 v73, v6, v10
    ds_bpermute_b32 v74, v7, v10
    ds_bpermute_b32 v75, v8, v10
    ds_write_b64 v22, v[10:11] offset:6144
    v_readlane_b32 s92, v16, 63
    s_nop 1
    v_mov_b32 v19, s92
    ds_write_b32 v29, v19 offset:12
    v_and_b32 v108, 3, v108
    v_lshlrev_b32 v108, 2, v108
    v_and_b32 v109, 3, v109
    v_lshlrev_b32 v109, 2, v109
    v_and_b32 v110, 3, v110
    v_lshlrev_b32 v110, 2, v110
    v_and_b32 v111, 3, v111
    v_lshlrev_b32 v111, 2, v111
    s_waitcnt lgkmcnt(2)
    v_lshl_add_u32 v108, v72, 4, v108
    v_lshl_add_u32 v109, v73, 4, v109
    v_lshl_add_u32 v110, v74, 4, v110
    v_lshl_add_u32 v111, v75, 4, v111
    ds_write_b128 v21, v[108:111] offset:0
    s_mov_b64 exec, 1
    ds_add_u32 v29, v30 offset:24
    s_mov_b64 exec, -1
K_S3DONE:
    s_waitcnt lgkmcnt(0)
    s_cmp_le_u32 s95, 0
    s_cbranch_scc1 FS10
    v_and_b32 v28, -4, v67
    v_mad_u32_u24 v67, v28, 3, v67
    v_and_b32 v66, 0xffffff00, v66
    v_and_b32 v28, -4, v71
    v_mad_u32_u24 v71, v28, 3, v71
    v_and_b32 v70, 0xffffff00, v70
    v_and_b32 v28, -4, v75
    v_mad_u32_u24 v75, v28, 3, v75
    v_and_b32 v74, 0xffffff00, v74
    v_and_b32 v28, -4, v79
    v_mad_u32_u24 v79, v28, 3, v79
    v_and_b32 v78, 0xffffff00, v78
    v_and_b32 v28, -4, v83
    v_mad_u32_u24 v83, v28, 3, v83
    v_and_b32 v82, 0xffffff00, v82
    v_and_b32 v28, -4, v87
    v_mad_u32_u24 v87, v28, 3, v87
    v_and_b32 v86, 0xffffff00, v86
    s_cmp_le_u32 s95, 6
    s_cbranch_scc1 FS10
    v_and_b32 v28, -4, v91
    v_mad_u32_u24 v91, v28, 3, v91
    v_and_b32 v90, 0xffffff00, v90
    v_and_b32 v28, -4, v95
    v_mad_u32_u24 v95, v28, 3, v95
    v_and_b32 v94, 0xffffff00, v94
    v_and_b32 v28, -4, v99
    v_mad_u32_u24 v99, v28, 3, v99
    v_and_b32 v98, 0xffffff00, v98
    s_cmp_le_u32 s95, 9
    s_cbranch_scc1 FS10
    v_and_b32 v28, -4, v103
    v_mad_u32_u24 v103, v28, 3, v103
    v_and_b32 v102, 0xffffff00, v102
    v_and_b32 v28, -4, v107
    v_mad_u32_u24 v107, v28, 3, v107
    v_and_b32 v106, 0xffffff00, v106
    v_and_b32 v28, -4, v111
    v_mad_u32_u24 v111, v28, 3, v111
    v_and_b32 v110, 0xffffff00, v110
    s_cmp_le_u32 s95, 12
    s_cbranch_scc1 FS10
    v_and_b32 v28, -4, v115
    v_mad_u32_u24 v115, v28, 3, v115
    v_and_b32 v114, 0xffffff00, v114
    v_and_b32 v28, -4, v119
    v_mad_u32_u24 v119, v28, 3, v119
    v_and_b32 v118, 0xffffff00, v118
    v_and_b32 v28, -4, v123
    v_mad_u32_u24 v123, v28, 3, v123
    v_and_b32 v122, 0xffffff00, v122
    s_cmp_le_u32 s95, 15
    s_cbranch_scc1 FS10
    v_and_b32 v28, -4, v127
    v_mad_u32_u24 v127, v28, 3, v127
    v_and_b32 v126, 0xffffff00, v126
    v_and_b32 v28, -4, v39
    v_mad_u32_u24 v39, v28, 3, v39
    v_and_b32 v38, 0xffffff00, v38
    v_and_b32 v28, -4, v43
    v_mad_u32_u24 v43, v28, 3, v43
    v_and_b32 v42, 0xffffff00, v42
FS10:
    s_waitcnt vmcnt(0)
    s_cmp_ge_u32 s26, 8
    s_cbranch_scc1 K_AR6
    s_mov_b64 exec, 1
    ds_add_u32 v29, v30 offset:780
    s_mov_b64 exec, -1
K_AR6:
    v_mov_b32 v31, 1560
K_B3:
    ds_read_b32 v28, v31
    s_waitcnt lgkmcnt(0)
    v_readfirstlane_b32 s3, v28
    s_nop 0
    s_cmp_ge_u32 s3, 3
    s_cbranch_scc1 K_B3_OK
    s_sleep 1
    s_branch K_B3
K_B3_OK:
    ds_read_b32 v28, v29 offset:12
    s_cmp_le_u32 s95, 0
    s_cbranch_scc1 FS11
    s_mov_b64 exec, s[64:65]
    ds_read_b32 v44, v44 offset:0
    s_mov_b64 exec, s[66:67]
    ds_read_b32 v45, v45 offset:0
    s_mov_b64 exec, s[68:69]
    ds_read_b32 v46, v46 offset:0
    s_mov_b64 exec, s[70:71]
    ds_read_b32 v47, v47 offset:0
    s_mov_b64 exec, s[72:73]
    ds_read_b32 v48, v48 offset:0
    s_mov_b64 exec, s[74:75]
    ds_read_b32 v49, v49 offset:0
    s_cmp_le_u32 s95, 6
    s_cbranch_scc1 FS11
    s_mov_b64 exec, s[76:77]
    ds_read_b32 v50, v50 offset:0
    s_mov_b64 exec, s[78:79]
    ds_read_b32 v51, v51 offset:0
    s_mov_b64 exec, s[80:81]
    ds_read_b32 v52, v52 offset:0
    s_cmp_le_u32 s95, 9
    s_cbranch_scc1 FS11
    s_mov_b64 exec, s[82:83]
    ds_read_b32 v53, v53 offset:0
    s_mov_b64 exec, s[84:85]
    ds_read_b32 v54, v54 offset:0
    s_mov_b64 exec, s[86:87]
    ds_read_b32 v55, v55 offset:0
    s_cmp_le_u32 s95, 12
    s_cbranch_scc1 FS11
    s_mov_b64 exec, s[36:37]
    ds_read_b32 v56, v56 offset:0
    s_mov_b64 exec, s[38:39]
    ds_read_b32 v57, v57 offset:0
    s_mov_b64 exec, s[40:41]
    ds_read_b32 v58, v58 offset:0
    s_cmp_le_u32 s95, 15
    s_cbranch_scc1 FS11
    s_mov_b64 exec, s[42:43]
    ds_read_b32 v59, v59 offset:0
    s_mov_b64 exec, s[44:45]
    ds_read_b32 v60, v60 offset:0
    s_mov_b64 exec, s[46:47]
    ds_read_b32 v61, v61 offset:0
FS11:
    s_mov_b64 exec, -1
    ds_read_b64 v[2:3], v22 offset:6144
    s_waitcnt lgkmcnt(0)
    v_readfirstlane_b32 s90, v28
    s_nop 0
    s_cmp_gt_u32 s90, 352
    s_cbranch_scc1 K_NOFIT
    s_cmp_le_u32 s94, 256
    s_cbranch_scc1 K_FITS
K_NOFIT:
    s_cmp_ge_u32 s26, 11
    s_cbranch_scc1 K_AR5
    s_mov_b64 exec, 1
    ds_add_u32 v29, v30 offset:28
    s_mov_b64 exec, -1
K_AR5:
    s_lshl_b32 s54, s54, 1
    s_lshr_b32 s52, s52, 2
    s_max_u32 s52, s52, 1
K_AGAIN:
    s_barrier
    v_lshlrev_b32 v5, 1, v0
    v_and_b32 v5, 0x7fc, v5
    v_mov_b32 v6, 0
    ds_write_b32 v5, v6
    s_waitcnt vmcnt(0) lgkmcnt(0)
    s_barrier
    s_branch K_RELOAD
K_FITS:
    s_cmp_le_u32 s95, 0
    s_cbranch_scc1 FS12
    s_mov_b64 exec, s[64:65]
    v_add_lshl_u32 v44, v44, v67, 2
    v_add_u32 v67, v44, v44
    ds_write_b32 v44, v66 offset:31488
    ds_write_b64 v67, v[64:65] offset:54016
    s_mov_b64 exec, s[66:67]
    v_add_lshl_u32 v45, v45, v71, 2
    v_add_u32 v71, v45, v45
    ds_write_b32 v45, v70 offset:31488
    ds_write_b64 v71, v[68:69] offset:54016
    s_mov_b64 exec, s[68:69]
    v_add_lshl_u32 v46, v46, v75, 2
    v_add_u32 v75, v46, v46
    ds_write_b32 v46, v74 offset:31488
    ds_write_b64 v75, v[72:73] offset:54016
    s_mov_b64 exec, s[70:71]
    v_add_lshl_u32 v47, v47, v79, 2
    v_add_u32 v79, v47, v47
    ds_write_b32 v47, v78 offset:31488
    ds_write_b64 v79, v[76:77] offset:54016
    s_mov_b64 exec, s[72:73]
    v_add_lshl_u32 v48, v48, v83, 2
    v_add_u32 v83, v48, v48
    ds_write_b32 v48, v82 offset:31488
    ds_write_b64 v83, v[80:81] offset:54016
    s_mov_b64 exec, s[74:75]
    v_add_lshl_u32 v49, v49, v87, 2
    v_add_u32 v87, v49, v49
    ds_write_b32 v49, v86 offset:31488
    ds_write_b64 v87, v[84:85] offset:54016
    s_cmp_le_u32 s95, 6
    s_cbranch_scc1 FS12
    s_mov_b64 exec, s[76:77]
    v_add_lshl_u32 v50, v50, v91, 2
    v_add_u32 v91, v50, v50
    ds_write_b32 v50, v90 offset:31488
    ds_write_b64 v91, v[88:89] offset:54016
    s_mov_b64 exec, s[78:79]
    v_add_lshl_u32 v51, v51, v95, 2
    v_add_u32 v95, v51, v51
    ds_write_b32 v51, v94 offset:31488
    ds_write_b64 v95, v[92:93] offset:54016
    s_mov_b64 exec, s[80:81]
    v_add_lshl_u32 v52, v52, v99, 2
    v_add_u32 v99, v52, v52
    ds_write_b32 v52, v98 offset:31488
    ds_write_b64 v99, v[96:97] offset:54016
    s_cmp_le_u32 s95, 9
    s_cbranch_scc1 FS12
    s_mov_b64 exec, s[82:83]
    v_add_lshl_u32 v53, v53, v103, 2
    v_add_u32 v103, v53, v53
    ds_write_b32 v53, v102 offset:31488
    ds_write_b64 v103, v[100:101] offset:54016
    s_mov_b64 exec, s[84:85]
    v_add_lshl_u32 v54, v54, v107, 2
    v_add_u32 v107, v54, v54
    ds_write_b32 v54, v106 offset:31488
    ds_write_b64 v107, v[104:105] offset:54016
    s_mov_b64 exec, s[86:87]
    v_add_lshl_u32 v55, v55, v111, 2
    v_add_u32 v111, v55, v55
    ds_write_b32 v55, v110 offset:31488
    ds_write_b64 v111, v[108:109] offset:54016
    s_cmp_le_u32 s95, 12
    s_cbranch_scc1 FS12
    s_mov_b64 exec, s[36:37]
    v_add_lshl_u32 v56, v56, v115, 2
    v_add_u32 v115, v56, v56
    ds_write_b32 v56, v114 offset:31488
    ds_write_b64 v115, v[112:113] offset:54016
    s_mov_b64 exec, s[38:39]
    v_add_lshl_u32 v57, v57, v119, 2
    v_add_u32 v119, v57, v57
    ds_write_b32 v57, v118 offset:31488
    ds_write_b64 v119, v[116:117] offset:54016
    s_mov_b64 exec, s[40:41]
    v_add_lshl_u32 v58, v58, v123, 2
    v_add_u32 v123, v58, v58
    ds_write_b32 v58, v122 offset:31488
    ds_write_b64 v123, v[120:121] offset:54016
    s_cmp_le_u32 s95, 15
    s_cbranch_scc1 FS12
    s_mov_b64 exec, s[42:43]
    v_add_lshl_u32 v59, v59, v127, 2
    v_add_u32 v127, v59, v59
    ds_write_b32 v59, v126 offset:31488
    ds_write_b64 v127, v[124:125] offset:54016
    s_mov_b64 exec, s[44:45]
    v_add_lshl_u32 v60, v60, v39, 2
    v_add_u32 v39, v60, v60
    ds_write_b32 v60, v38 offset:31488
    ds_write_b64 v39, v[36:37] offset:54016
    s_mov_b64 exec, s[46:47]
    v_add_lshl_u32 v61, v61, v43, 2
    v_add_u32 v43, v61, v61
    ds_write_b32 v61, v42 offset:31488
    ds_write_b64 v43, v[40:41] offset:54016
FS12:
    s_mov_b64 exec, -1
    s_cmp_ge_u32 s26, 11
    s_cbranch_scc1 K_AR4
    s_mov_b64 exec, 1
    ds_add_u32 v29, v30 offset:28
    s_mov_b64 exec, -1
K_AR4:
    s_and_b32 s3, s49, 1
    s_lshl_b32 s3, s3, 1
    s_lshl2_add_u32 s3, s48, s3
    s_cmp_lt_u32 s3, 49
    s_cbranch_scc1 S_PRO
    v_mov_b32 v25, 1564
K_B4x:
    ds_read_b32 v24, v25
    s_waitcnt lgkmcnt(0)
    v_readfirstlane_b32 s3, v24
    s_nop 0
    s_cmp_ge_u32 s3, 11
    s_cbranch_scc1 K_B4x_OK
    s_sleep 2
    s_branch K_B4x
K_B4x_OK:
    s_branch S_DONE
S_PRO:
    v_and_b32 v18, 15, v1
    v_lshrrev_b32 v19, 4, v1
    v_lshlrev_b32 v6, 4, v19
    v_add_u32 v6, 31488, v6
    v_lshlrev_b32 v7, 3, v18
    v_add_u32 v7, 54022, v7
    v_lshlrev_b32 v11, 2, v19
    v_and_b32 v5, 7, v1
    v_lshlrev_b32 v5, 4, v5
    v_bfe_u32 v9, v1, 3, 1
    v_lshrrev_b32 v10, 5, v1
    v_and_b32 v8, 16, v1
    v_add_u32 v8, 6656, v8
    v_lshl_add_u32 v11, v9, 4, v11
    v_lshlrev_b32 v14, 4, v1
    v_add_u32 v14, 101120, v14
    ds_read_b128 v[80:83], v14 offset:0
    ds_read_b128 v[84:87], v14 offset:1024
    ds_read_b128 v[88:91], v14 offset:2048
    ds_read_b128 v[92:95], v14 offset:3072
    ds_read_b128 v[96:99], v14 offset:4096
    ds_read_b128 v[100:103], v14 offset:5120
    ds_read_b128 v[104:107], v14 offset:6144
    ds_read_b128 v[108:111], v14 offset:7168
    s_and_b32 s3, s49, 1
    s_lshl_b32 s3, s3, 1
    s_lshl2_add_u32 s3, s48, s3
    s_lshl_b32 s3, s3, 4
    s_add_u32 s3, s3, 5120
    v_add_u32 v18, s3, v11
    ds_read_b32 v18, v18
    s_waitcnt lgkmcnt(0)
    v_add_lshl_u32 v18, v18, s96, 10
    v_add3_u32 v18, v18, v5, s24
    buffer_load_dwordx4 v[120:123], v18, s[12:15], 0 offen
    v_mov_b32 v25, 1564
K_B4:
    ds_read_b32 v24, v25
    s_waitcnt lgkmcnt(0)
    v_readfirstlane_b32 s3, v24
    s_nop 0
    s_cmp_ge_u32 s3, 11
    s_cbranch_scc1 K_B4_OK
    s_sleep 1
    s_branch K_B4
K_B4_OK:
    v_mov_b32 v25, 2352
K_B5:
    ds_read_b32 v24, v25
    s_waitcnt lgkmcnt(0)
    v_readfirstlane_b32 s3, v24
    s_nop 0
    s_cmp_ge_u32 s3, 1
    s_cbranch_scc1 K_B5_OK
    s_sleep 1
    s_branch K_B5
K_B5_OK:
S_NEXT:
    s_and_b32 s88, s49, 1
    s_lshl_b32 s88, s88, 1
    s_lshl2_add_u32 s88, s48, s88
    s_cmp_lt_u32 s88, 49
    s_cbranch_scc1 S_GO
    s_waitcnt vmcnt(0)
    s_branch S_DONE
S_GO:
    s_setprio 3
    s_add_u32 s91, s88, 1
    v_readlane_b32 s90, v2, s88
    v_readlane_b32 s93, v3, s88
    v_readlane_b32 s89, v3, s91
    s_nop 0
    s_max_u32 s93, s93, s89
    s_lshl_b32 s91, s88, 4
    s_add_u32 s91, s91, 5120
    v_add_u32 v18, s91, v11
    ds_read_b32 v17, v18
    s_add_u32 s89, s93, 3
    s_lshr_b32 s89, s89, 2
    s_sub_u32 s93, s93, 1
    s_and_b32 s93, s93, 3
    s_add_u32 s93, s93, 1
    s_lshl_b32 s91, s90, 6
    s_lshl_b32 s92, s90, 7
    v_add_u32 v14, s91, v6
    v_add_u32 v15, s92, v7
    s_lshl_b32 s91, s89, 6
    s_lshl_b32 s92, s89, 7
    v_mad_u32_u24 v14, v9, s91, v14
    v_mad_u32_u24 v15, v10, s92, v15
    ds_read_b128 v[24:27], v14 offset:0
    ds_read_u16 v20, v15 offset:0
    ds_read_b128 v[28:31], v14 offset:64
    ds_read_u16 v21, v15 offset:128
    v_mov_b32 v124, 0
    v_mov_b32 v125, 0
    v_mov_b32 v126, 0
    v_mov_b32 v127, 0
    v_mov_b32 v22, 0
    v_mov_b32 v23, 0
    v_mov_b32 v12, 0
    v_mov_b32 v13, 0
    s_waitcnt lgkmcnt(0)
    v_add_lshl_u32 v17, v17, s96, 10
    v_add3_u32 v17, v17, v5, s24
    s_cmp_eq_u32 s89, 0
    s_cbranch_scc1 S_EPI
    v_lshrrev_b32 v24, 1, v24
    v_lshrrev_b32 v25, 1, v25
    v_lshrrev_b32 v26, 1, v26
    v_lshrrev_b32 v27, 1, v27
    v_add_u32 v24, v24, v5
    v_add_u32 v25, v25, v5
    v_add_u32 v26, v26, v5
    v_add_u32 v27, v27, v5
    v_add_u32 v20, v20, v8
    ds_read_b128 v[112:115], v20
    s_cmp_eq_u32 s89, 1
    s_cselect_b32 s91, s93, 4
    buffer_load_dwordx4 v[32:35], v24, s[8:11], 0 offen sc1
    s_cmp_eq_u32 s91, 1
    s_cbranch_scc1 S_LOOP
    buffer_load_dwordx4 v[36:39], v25, s[8:11], 0 offen sc1
    s_cmp_eq_u32 s91, 2
    s_cbranch_scc1 S_LOOP
    buffer_load_dwordx4 v[40:43], v26, s[8:11], 0 offen sc1
    s_cmp_eq_u32 s91, 3
    s_cbranch_scc1 S_LOOP
    buffer_load_dwordx4 v[44:47], v27, s[8:11], 0 offen sc1
S_LOOP:
    s_waitcnt lgkmcnt(0)
    v_mfma_f32_16x16x32_bf16 v[64:67], v[112:115], v[84:87], 0
    v_mfma_f32_16x16x32_bf16 v[68:71], v[112:115], v[92:95], 0
    v_mfma_f32_16x16x32_bf16 v[72:75], v[112:115], v[100:103], 0
    v_mfma_f32_16x16x32_bf16 v[76:79], v[112:115], v[108:111], 0
    s_sub_u32 s89, s89, 1
    s_cmp_eq_u32 s89, 0
    s_cbranch_scc1 S_LAST0
    v_lshrrev_b32 v28, 1, v28
    v_lshrrev_b32 v29, 1, v29
    v_lshrrev_b32 v30, 1, v30
    v_lshrrev_b32 v31, 1, v31
    v_add_u32 v28, v28, v5
    v_add_u32 v29, v29, v5
    v_add_u32 v30, v30, v5
    v_add_u32 v31, v31, v5
    v_add_u32 v21, v21, v8
    ds_read_b128 v[116:119], v21
    s_cmp_eq_u32 s89, 1
    s_cbranch_scc1 S_BP0
S_BF0:
    buffer_load_dwordx4 v[48:51], v28, s[8:11], 0 offen sc1
    buffer_load_dwordx4 v[52:55], v29, s[8:11], 0 offen sc1
    buffer_load_dwordx4 v[56:59], v30, s[8:11], 0 offen sc1
    buffer_load_dwordx4 v[60:63], v31, s[8:11], 0 offen sc1
    ds_read_b128 v[24:27], v14 offset:128
    ds_read_u16 v20, v15 offset:256
    s_waitcnt vmcnt(4)
S_BJ0:
    v_fmac_f32 v125, v32, v64
    v_fmac_f32 v127, v33, v68
    v_fmac_f32 v23, v34, v72
    v_fmac_f32 v13, v35, v76
    v_fmac_f32 v125, v36, v65
    v_fmac_f32 v127, v37, v69
    v_fmac_f32 v23, v38, v73
    v_fmac_f32 v13, v39, v77
    v_fmac_f32 v125, v40, v66
    v_fmac_f32 v127, v41, v70
    v_fmac_f32 v23, v42, v74
    v_fmac_f32 v13, v43, v78
    v_fmac_f32 v125, v44, v67
    v_fmac_f32 v127, v45, v71
    v_fmac_f32 v23, v46, v75
    v_fmac_f32 v13, v47, v79
    v_mfma_f32_16x16x32_bf16 v[64:67], v[112:115], v[80:83], 0
    v_mfma_f32_16x16x32_bf16 v[68:71], v[112:115], v[88:91], 0
    v_mfma_f32_16x16x32_bf16 v[72:75], v[112:115], v[96:99], 0
    v_mfma_f32_16x16x32_bf16 v[76:79], v[112:115], v[104:107], 0
    v_lshlrev_b32 v32, 16, v32
    v_lshlrev_b32 v33, 16, v33
    v_lshlrev_b32 v34, 16, v34
    v_lshlrev_b32 v35, 16, v35
    v_lshlrev_b32 v36, 16, v36
    v_lshlrev_b32 v37, 16, v37
    v_lshlrev_b32 v38, 16, v38
    v_lshlrev_b32 v39, 16, v39
    v_lshlrev_b32 v40, 16, v40
    v_lshlrev_b32 v41, 16, v41
    v_lshlrev_b32 v42, 16, v42
    v_lshlrev_b32 v43, 16, v43
    v_lshlrev_b32 v44, 16, v44
    v_lshlrev_b32 v45, 16, v45
    v_lshlrev_b32 v46, 16, v46
    v_lshlrev_b32 v47, 16, v47
    v_fmac_f32 v124, v32, v64
    v_fmac_f32 v126, v33, v68
    v_fmac_f32 v22, v34, v72
    v_fmac_f32 v12, v35, v76
    v_fmac_f32 v124, v36, v65
    v_fmac_f32 v126, v37, v69
    v_fmac_f32 v22, v38, v73
    v_fmac_f32 v12, v39, v77
    v_fmac_f32 v124, v40, v66
    v_fmac_f32 v126, v41, v70
    v_fmac_f32 v22, v42, v74
    v_fmac_f32 v12, v43, v78
    v_fmac_f32 v124, v44, v67
    v_fmac_f32 v126, v45, v71
    v_fmac_f32 v22, v46, v75
    v_fmac_f32 v12, v47, v79
    v_add_u32 v14, 128, v14
    v_add_u32 v15, 256, v15
    s_waitcnt lgkmcnt(0)
    v_mfma_f32_16x16x32_bf16 v[64:67], v[116:119], v[84:87], 0
    v_mfma_f32_16x16x32_bf16 v[68:71], v[116:119], v[92:95], 0
    v_mfma_f32_16x16x32_bf16 v[72:75], v[116:119], v[100:103], 0
    v_mfma_f32_16x16x32_bf16 v[76:79], v[116:119], v[108:111], 0
    s_sub_u32 s89, s89, 1
    s_cmp_eq_u32 s89, 0
    s_cbranch_scc1 S_LAST1
    v_lshrrev_b32 v24, 1, v24
    v_lshrrev_b32 v25, 1, v25
    v_lshrrev_b32 v26, 1, v26
    v_lshrrev_b32 v27, 1, v27
    v_add_u32 v24, v24, v5
    v_add_u32 v25, v25, v5
    v_add_u32 v26, v26, v5
    v_add_u32 v27, v27, v5
    v_add_u32 v20, v20, v8
    ds_read_b128 v[112:115], v20
    s_cmp_eq_u32 s89, 1
    s_cbranch_scc1 S_BP1
S_BF1:
    buffer_load_dwordx4 v[32:35], v24, s[8:11], 0 offen sc1
    buffer_load_dwordx4 v[36:39], v25, s[8:11], 0 offen sc1
    buffer_load_dwordx4 v[40:43], v26, s[8:11], 0 offen sc1
    buffer_load_dwordx4 v[44:47], v27, s[8:11], 0 offen sc1
    ds_read_b128 v[28:31], v14 offset:64
    ds_read_u16 v21, v15 offset:128
    s_waitcnt vmcnt(4)
S_BJ1:
    v_fmac_f32 v125, v48, v64
    v_fmac_f32 v127, v49, v68
    v_fmac_f32 v23, v50, v72
    v_fmac_f32 v13, v51, v76
    v_fmac_f32 v125, v52, v65
    v_fmac_f32 v127, v53, v69
    v_fmac_f32 v23, v54, v73
    v_fmac_f32 v13, v55, v77
    v_fmac_f32 v125, v56, v66
    v_fmac_f32 v127, v57, v70
    v_fmac_f32 v23, v58, v74
    v_fmac_f32 v13, v59, v78
    v_fmac_f32 v125, v60, v67
    v_fmac_f32 v127, v61, v71
    v_fmac_f32 v23, v62, v75
    v_fmac_f32 v13, v63, v79
    v_mfma_f32_16x16x32_bf16 v[64:67], v[116:119], v[80:83], 0
    v_mfma_f32_16x16x32_bf16 v[68:71], v[116:119], v[88:91], 0
    v_mfma_f32_16x16x32_bf16 v[72:75], v[116:119], v[96:99], 0
    v_mfma_f32_16x16x32_bf16 v[76:79], v[116:119], v[104:107], 0
    v_lshlrev_b32 v48, 16, v48
    v_lshlrev_b32 v49, 16, v49
    v_lshlrev_b32 v50, 16, v50
    v_lshlrev_b32 v51, 16, v51
    v_lshlrev_b32 v52, 16, v52
    v_lshlrev_b32 v53, 16, v53
    v_lshlrev_b32 v54, 16, v54
    v_lshlrev_b32 v55, 16, v55
    v_lshlrev_b32 v56, 16, v56
    v_lshlrev_b32 v57, 16, v57
    v_lshlrev_b32 v58, 16, v58
    v_lshlrev_b32 v59, 16, v59
    v_lshlrev_b32 v60, 16, v60
    v_lshlrev_b32 v61, 16, v61
    v_lshlrev_b32 v62, 16, v62
    v_lshlrev_b32 v63, 16, v63
    v_fmac_f32 v124, v48, v64
    v_fmac_f32 v126, v49, v68
    v_fmac_f32 v22, v50, v72
    v_fmac_f32 v12, v51, v76
    v_fmac_f32 v124, v52, v65
    v_fmac_f32 v126, v53, v69
    v_fmac_f32 v22, v54, v73
    v_fmac_f32 v12, v55, v77
    v_fmac_f32 v124, v56, v66
    v_fmac_f32 v126, v57, v70
    v_fmac_f32 v22, v58, v74
    v_fmac_f32 v12, v59, v78
    v_fmac_f32 v124, v60, v67
    v_fmac_f32 v126, v61, v71
    v_fmac_f32 v22, v62, v75
    v_fmac_f32 v12, v63, v79
    s_branch S_LOOP
S_BP0:
    s_cmp_eq_u32 s93, 4
    s_cbranch_scc1 S_BF0
    buffer_load_dwordx4 v[48:51], v28, s[8:11], 0 offen sc1
    s_cmp_lg_u32 s93, 1
    s_cbranch_scc1 S_BQ00
    s_waitcnt vmcnt(1)
    s_branch S_BJ0
S_BQ00:
    buffer_load_dwordx4 v[52:55], v29, s[8:11], 0 offen sc1
    s_cmp_lg_u32 s93, 2
    s_cbranch_scc1 S_BQ01
    s_waitcnt vmcnt(2)
    s_branch S_BJ0
S_BQ01:
    buffer_load_dwordx4 v[56:59], v30, s[8:11], 0 offen sc1
    s_waitcnt vmcnt(3)
    s_branch S_BJ0
S_BP1:
    s_cmp_eq_u32 s93, 4
    s_cbranch_scc1 S_BF1
    buffer_load_dwordx4 v[32:35], v24, s[8:11], 0 offen sc1
    s_cmp_lg_u32 s93, 1
    s_cbranch_scc1 S_BQ10
    s_waitcnt vmcnt(1)
    s_branch S_BJ1
S_BQ10:
    buffer_load_dwordx4 v[36:39], v25, s[8:11], 0 offen sc1
    s_cmp_lg_u32 s93, 2
    s_cbranch_scc1 S_BQ11
    s_waitcnt vmcnt(2)
    s_branch S_BJ1
S_BQ11:
    buffer_load_dwordx4 v[40:43], v26, s[8:11], 0 offen sc1
    s_waitcnt vmcnt(3)
    s_branch S_BJ1
S_LAST0:
    s_waitcnt vmcnt(0)
    s_nop 3
    v_fmac_f32 v125, v32, v64
    v_fmac_f32 v127, v33, v68
    v_fmac_f32 v23, v34, v72
    v_fmac_f32 v13, v35, v76
    s_cmp_eq_u32 s93, 1
    s_cbranch_scc1 S_LT0
    v_fmac_f32 v125, v36, v65
    v_fmac_f32 v127, v37, v69
    v_fmac_f32 v23, v38, v73
    v_fmac_f32 v13, v39, v77
    s_cmp_eq_u32 s93, 2
    s_cbranch_scc1 S_LT0
    v_fmac_f32 v125, v40, v66
    v_fmac_f32 v127, v41, v70
    v_fmac_f32 v23, v42, v74
    v_fmac_f32 v13, v43, v78
    s_cmp_eq_u32 s93, 3
    s_cbranch_scc1 S_LT0
    v_fmac_f32 v125, v44, v67
    v_fmac_f32 v127, v45, v71
    v_fmac_f32 v23, v46, v75
    v_fmac_f32 v13, v47, v79
S_LT0:
    v_mfma_f32_16x16x32_bf16 v[64:67], v[112:115], v[80:83], 0
    v_mfma_f32_16x16x32_bf16 v[68:71], v[112:115], v[88:91], 0
    v_mfma_f32_16x16x32_bf16 v[72:75], v[112:115], v[96:99], 0
    v_mfma_f32_16x16x32_bf16 v[76:79], v[112:115], v[104:107], 0
    v_lshlrev_b32 v32, 16, v32
    v_lshlrev_b32 v33, 16, v33
    v_lshlrev_b32 v34, 16, v34
    v_lshlrev_b32 v35, 16, v35
    s_nop 0
    v_fmac_f32 v124, v32, v64
    v_fmac_f32 v126, v33, v68
    v_fmac_f32 v22, v34, v72
    v_fmac_f32 v12, v35, v76
    s_cmp_eq_u32 s93, 1
    s_cbranch_scc1 S_EPI
    v_lshlrev_b32 v36, 16, v36
    v_lshlrev_b32 v37, 16, v37
    v_lshlrev_b32 v38, 16, v38
    v_lshlrev_b32 v39, 16, v39
    v_fmac_f32 v124, v36, v65
    v_fmac_f32 v126, v37, v69
    v_fmac_f32 v22, v38, v73
    v_fmac_f32 v12, v39, v77
    s_cmp_eq_u32 s93, 2
    s_cbranch_scc1 S_EPI
    v_lshlrev_b32 v40, 16, v40
    v_lshlrev_b32 v41, 16, v41
    v_lshlrev_b32 v42, 16, v42
    v_lshlrev_b32 v43, 16, v43
    v_fmac_f32 v124, v40, v66
    v_fmac_f32 v126, v41, v70
    v_fmac_f32 v22, v42, v74
    v_fmac_f32 v12, v43, v78
    s_cmp_eq_u32 s93, 3
    s_cbranch_scc1 S_EPI
    v_lshlrev_b32 v44, 16, v44
    v_lshlrev_b32 v45, 16, v45
    v_lshlrev_b32 v46, 16, v46
    v_lshlrev_b32 v47, 16, v47
    v_fmac_f32 v124, v44, v67
    v_fmac_f32 v126, v45, v71
    v_fmac_f32 v22, v46, v75
    v_fmac_f32 v12, v47, v79
    s_branch S_EPI
S_LAST1:
    s_waitcnt vmcnt(0)
    s_nop 3
    v_fmac_f32 v125, v48, v64
    v_fmac_f32 v127, v49, v68
    v_fmac_f32 v23, v50, v72
    v_fmac_f32 v13, v51, v76
    s_cmp_eq_u32 s93, 1
    s_cbranch_scc1 S_LT1
    v_fmac_f32 v125, v52, v65
    v_fmac_f32 v127, v53, v69
    v_fmac_f32 v23, v54, v73
    v_fmac_f32 v13, v55, v77
    s_cmp_eq_u32 s93, 2
    s_cbranch_scc1 S_LT1
    v_fmac_f32 v125, v56, v66
    v_fmac_f32 v127, v57, v70
    v_fmac_f32 v23, v58, v74
    v_fmac_f32 v13, v59, v78
    s_cmp_eq_u32 s93, 3
    s_cbranch_scc1 S_LT1
    v_fmac_f32 v125, v60, v67
    v_fmac_f32 v127, v61, v71
    v_fmac_f32 v23, v62, v75
    v_fmac_f32 v13, v63, v79
S_LT1:
    v_mfma_f32_16x16x32_bf16 v[64:67], v[116:119], v[80:83], 0
    v_mfma_f32_16x16x32_bf16 v[68:71], v[116:119], v[88:91], 0
    v_mfma_f32_16x16x32_bf16 v[72:75], v[116:119], v[96:99], 0
    v_mfma_f32_16x16x32_bf16 v[76:79], v[116:119], v[104:107], 0
    v_lshlrev_b32 v48, 16, v48
    v_lshlrev_b32 v49, 16, v49
    v_lshlrev_b32 v50, 16, v50
    v_lshlrev_b32 v51, 16, v51
    s_nop 0
    v_fmac_f32 v124, v48, v64
    v_fmac_f32 v126, v49, v68
    v_fmac_f32 v22, v50, v72
    v_fmac_f32 v12, v51, v76
    s_cmp_eq_u32 s93, 1
    s_cbranch_scc1 S_EPI
    v_lshlrev_b32 v52, 16, v52
    v_lshlrev_b32 v53, 16, v53
    v_lshlrev_b32 v54, 16, v54
    v_lshlrev_b32 v55, 16, v55
    v_fmac_f32 v124, v52, v65
    v_fmac_f32 v126, v53, v69
    v_fmac_f32 v22, v54, v73
    v_fmac_f32 v12, v55, v77
    s_cmp_eq_u32 s93, 2
    s_cbranch_scc1 S_EPI
    v_lshlrev_b32 v56, 16, v56
    v_lshlrev_b32 v57, 16, v57
    v_lshlrev_b32 v58, 16, v58
    v_lshlrev_b32 v59, 16, v59
    v_fmac_f32 v124, v56, v66
    v_fmac_f32 v126, v57, v70
    v_fmac_f32 v22, v58, v74
    v_fmac_f32 v12, v59, v78
    s_cmp_eq_u32 s93, 3
    s_cbranch_scc1 S_EPI
    v_lshlrev_b32 v60, 16, v60
    v_lshlrev_b32 v61, 16, v61
    v_lshlrev_b32 v62, 16, v62
    v_lshlrev_b32 v63, 16, v63
    v_fmac_f32 v124, v60, v67
    v_fmac_f32 v126, v61, v71
    v_fmac_f32 v22, v62, v75
    v_fmac_f32 v12, v63, v79
S_EPI:
    s_cmp_eq_u32 s53, 0
    s_cbranch_scc1 S_FIN
    v_lshlrev_b32 v18, 1, v17
    s_cmp_lg_u32 s54, 0
    s_cbranch_scc1 S_NOLD
    buffer_load_dwordx2 v[32:33], v18, s[28:31], 0 offen offset:0 sc0 sc1
    buffer_load_dwordx2 v[34:35], v18, s[28:31], 0 offen offset:8 sc0 sc1
    buffer_load_dwordx2 v[36:37], v18, s[28:31], 0 offen offset:16 sc0 sc1
    buffer_load_dwordx2 v[38:39], v18, s[28:31], 0 offen offset:24 sc0 sc1
    s_waitcnt vmcnt(0)
    v_add_f32 v124, v124, v32
    v_add_f32 v125, v125, v33
    v_add_f32 v126, v126, v34
    v_add_f32 v127, v127, v35
    v_add_f32 v22, v22, v36
    v_add_f32 v23, v23, v37
    v_add_f32 v12, v12, v38
    v_add_f32 v13, v13, v39
S_NOLD:
    s_cmp_lg_u32 s55, 0
    s_cbranch_scc1 S_FIN
    v_mov_b32 v32, v124
    v_mov_b32 v33, v125
    buffer_store_dwordx2 v[32:33], v18, s[28:31], 0 offen offset:0 sc0 sc1
    v_mov_b32 v34, v126
    v_mov_b32 v35, v127
    buffer_store_dwordx2 v[34:35], v18, s[28:31], 0 offen offset:8 sc0 sc1
    v_mov_b32 v36, v22
    v_mov_b32 v37, v23
    buffer_store_dwordx2 v[36:37], v18, s[28:31], 0 offen offset:16 sc0 sc1
    v_mov_b32 v38, v12
    v_mov_b32 v39, v13
    buffer_store_dwordx2 v[38:39], v18, s[28:31], 0 offen offset:24 sc0 sc1
    s_waitcnt vmcnt(0)
    s_branch S_DONE
S_FIN:
    s_waitcnt vmcnt(0)
    v_cvt_pk_bf16_f32 v124, 0, v124
    v_cvt_pk_bf16_f32 v125, 0, v125
    v_lshlrev_b32 v18, 16, v120
    v_and_b32 v19, 0xffff0000, v120
    v_add_f32 v124, v124, v18
    v_add_f32 v125, v125, v19
    v_cvt_pk_bf16_f32 v64, v124, v125
    v_cvt_pk_bf16_f32 v126, 0, v126
    v_cvt_pk_bf16_f32 v127, 0, v127
    v_lshlrev_b32 v18, 16, v121
    v_and_b32 v19, 0xffff0000, v121
    v_add_f32 v126, v126, v18
    v_add_f32 v127, v127, v19
    v_cvt_pk_bf16_f32 v65, v126, v127
    v_cvt_pk_bf16_f32 v22, 0, v22
    v_cvt_pk_bf16_f32 v23, 0, v23
    v_lshlrev_b32 v18, 16, v122
    v_and_b32 v19, 0xffff0000, v122
    v_add_f32 v22, v22, v18
    v_add_f32 v23, v23, v19
    v_cvt_pk_bf16_f32 v66, v22, v23
    v_cvt_pk_bf16_f32 v12, 0, v12
    v_cvt_pk_bf16_f32 v13, 0, v13
    v_lshlrev_b32 v18, 16, v123
    v_and_b32 v19, 0xffff0000, v123
    v_add_f32 v12, v12, v18
    v_add_f32 v13, v13, v19
    v_cvt_pk_bf16_f32 v67, v12, v13
    buffer_store_dwordx4 v[64:67], v17, s[16:19], 0 offen nt
S_DONE:
    s_setprio 2
    v_and_b32 v18, 15, v1
    v_lshrrev_b32 v19, 4, v1
    v_lshlrev_b32 v6, 4, v19
    v_add_u32 v6, 31488, v6
    v_lshlrev_b32 v7, 3, v18
    v_add_u32 v7, 54022, v7
    v_lshlrev_b32 v13, 2, v19
    v_lshlrev_b32 v14, 4, v1
    v_add_u32 v14, 99072, v14
    ds_read_b128 v[84:87], v14
    ds_read_b128 v[88:91], v14 offset:1024
    v_lshlrev_b32 v5, 4, v18
    v_lshlrev_b32 v8, 3, v19
    v_add_u32 v8, 6656, v8
    s_lshl_b32 s92, s49, 6
    v_lshl_add_u32 v12, v18, 2, s92
    v_lshlrev_b32 v124, 2, v18
    v_add_u32 v124, 109312, v124
    v_lshrrev_b32 v15, 2, v18
    v_and_b32 v18, 3, v18
    v_add_lshl_u32 v15, v13, v15, 3
    v_add_u32 v15, 54016, v15
    v_cmp_eq_u32 vcc, v18, v19
    v_mov_b32 v18, 1792
    s_nop 0
    v_cndmask_b32 v9, v18, v15, vcc
    v_cndmask_b32 v10, 0, 1, vcc
    v_lshlrev_b32 v11, 8, v10
    v_mov_b32 v25, 2356
K_B6:
    ds_read_b32 v24, v25
    s_waitcnt lgkmcnt(0)
    v_readfirstlane_b32 s3, v24
    s_nop 0
    s_cmp_ge_u32 s3, 1
    s_cbranch_scc1 K_B6_OK
    s_sleep 2
    s_branch K_B6
K_B6_OK:
V_NEXT:
    v_mov_b32 v18, 1540
    v_mov_b32 v19, 1
    s_mov_b64 exec, 1
    ds_add_rtn_u32 v19, v18, v19
    s_mov_b64 exec, -1
    s_waitcnt lgkmcnt(0)
    v_readfirstlane_b32 s88, v19
    s_nop 0
    s_cmp_ge_u32 s88, 49
    s_cbranch_scc1 V_DONE
    s_cmp_lt_u32 s88, 16
    s_cbranch_scc1 V_PJ
    s_setprio 1
    s_cmp_lt_u32 s88, 32
    s_cbranch_scc1 V_PJ
    s_setprio 0
V_PJ:
    v_readlane_b32 s90, v2, s88
    v_readlane_b32 s93, v3, s88
    s_lshl_b32 s91, s88, 4
    s_add_u32 s91, s91, 5120
    v_add_u32 v18, s91, v13
    ds_read_b32 v17, v18
    s_add_u32 s89, s93, 3
    s_lshr_b32 s89, s89, 2
    s_sub_u32 s93, s93, 1
    s_and_b32 s93, s93, 3
    s_add_u32 s93, s93, 1
    s_lshl_b32 s91, s90, 6
    s_lshl_b32 s92, s90, 7
    v_add_u32 v14, s91, v6
    v_add_u32 v15, s92, v7
    v_mad_u32_u24 v16, v10, s92, v9
    ds_read_b128 v[24:27], v14 offset:0
    ds_read_u16 v20, v15 offset:0
    ds_read_b128 v[28:31], v14 offset:64
    ds_read_u16 v21, v15 offset:128
    v_mov_b32 v104, 0
    v_mov_b32 v105, 0
    v_mov_b32 v106, 0
    v_mov_b32 v107, 0
    v_mov_b32 v108, 0
    v_mov_b32 v109, 0
    v_mov_b32 v112, 0
    v_mov_b32 v113, 0
    v_mov_b32 v114, 0
    v_mov_b32 v115, 0
    v_mov_b32 v116, 0
    v_mov_b32 v117, 0
    v_mov_b32 v118, 0
    v_mov_b32 v119, 0
    s_waitcnt lgkmcnt(0)
    v_lshl_add_u32 v18, v17, 8, v124
    ds_read_b32 v120, v18 offset:0
    ds_read_b32 v121, v18 offset:64
    ds_read_b32 v122, v18 offset:128
    v_add_lshl_u32 v17, v17, s96, 10
    v_add_u32 v17, v17, v12
    s_cmp_eq_u32 s89, 0
    s_cbranch_scc1 V_EPI
    v_add_u32 v24, v24, v5
    v_add_u32 v25, v25, v5
    v_add_u32 v26, v26, v5
    v_add_u32 v27, v27, v5
    v_add_u32 v20, v20, v8
    ds_read_b64 v[80:81], v20
    s_cmp_eq_u32 s89, 1
    s_cselect_b32 s91, s93, 4
    buffer_load_dwordx4 v[32:35], v24, s[4:7], 0 offen sc1
    s_cmp_eq_u32 s91, 1
    s_cbranch_scc1 V_LOOP
    buffer_load_dwordx4 v[36:39], v25, s[4:7], 0 offen sc1
    s_cmp_eq_u32 s91, 2
    s_cbranch_scc1 V_LOOP
    buffer_load_dwordx4 v[40:43], v26, s[4:7], 0 offen sc1
    s_cmp_eq_u32 s91, 3
    s_cbranch_scc1 V_LOOP
    buffer_load_dwordx4 v[44:47], v27, s[4:7], 0 offen sc1
V_LOOP:
    s_waitcnt lgkmcnt(0)
    v_mfma_f32_16x16x16_bf16 v[68:71], v[80:81], v[86:87], 0
    v_mfma_f32_16x16x16_bf16 v[76:79], v[80:81], v[90:91], 0
    v_mfma_f32_16x16x16_bf16 v[72:75], v[80:81], v[88:89], 0
    v_mfma_f32_16x16x16_bf16 v[64:67], v[80:81], v[84:85], 0
    ds_read_b64_tr_b16 v[92:93], v16
    ds_read_b64_tr_b16 v[94:95], v16 offset:128
    s_sub_u32 s89, s89, 1
    s_cmp_eq_u32 s89, 0
    s_cbranch_scc1 V_LAST0
    v_add_u32 v28, v28, v5
    v_add_u32 v29, v29, v5
    v_add_u32 v30, v30, v5
    v_add_u32 v31, v31, v5
    v_add_u32 v21, v21, v8
    ds_read_b64 v[82:83], v21
    s_cmp_eq_u32 s89, 1
    s_cbranch_scc1 V_BP0
V_BF0:
    buffer_load_dwordx4 v[48:51], v28, s[4:7], 0 offen sc1
    buffer_load_dwordx4 v[52:55], v29, s[4:7], 0 offen sc1
    buffer_load_dwordx4 v[56:59], v30, s[4:7], 0 offen sc1
    buffer_load_dwordx4 v[60:63], v31, s[4:7], 0 offen sc1
    ds_read_b128 v[24:27], v14 offset:128
    ds_read_u16 v20, v15 offset:256
    s_waitcnt vmcnt(4)
V_BJ0:
    v_fmac_f32 v106, v32, v68
    v_fmac_f32 v107, v33, v68
    v_fmac_f32 v109, v34, v68
    v_mul_f32 v76, v35, v76
    v_lshlrev_b32 v32, 16, v32
    v_lshlrev_b32 v33, 16, v33
    v_lshlrev_b32 v34, 16, v34
    v_lshlrev_b32 v35, 16, v35
    v_fmac_f32 v106, v36, v69
    v_fmac_f32 v107, v37, v69
    v_fmac_f32 v109, v38, v69
    v_mul_f32 v77, v39, v77
    v_lshlrev_b32 v36, 16, v36
    v_lshlrev_b32 v37, 16, v37
    v_lshlrev_b32 v38, 16, v38
    v_lshlrev_b32 v39, 16, v39
    v_fmac_f32 v106, v40, v70
    v_fmac_f32 v107, v41, v70
    v_fmac_f32 v109, v42, v70
    v_mul_f32 v78, v43, v78
    v_lshlrev_b32 v40, 16, v40
    v_lshlrev_b32 v41, 16, v41
    v_lshlrev_b32 v42, 16, v42
    v_lshlrev_b32 v43, 16, v43
    v_fmac_f32 v106, v44, v71
    v_fmac_f32 v107, v45, v71
    v_fmac_f32 v109, v46, v71
    v_mul_f32 v79, v47, v79
    v_lshlrev_b32 v44, 16, v44
    v_lshlrev_b32 v45, 16, v45
    v_lshlrev_b32 v46, 16, v46
    v_lshlrev_b32 v47, 16, v47
    v_mul_f32 v72, v35, v72
    v_mul_f32 v73, v39, v73
    v_mul_f32 v74, v43, v74
    v_mul_f32 v75, v47, v75
    v_cvt_pk_bf16_f32 v100, v76, v77
    v_cvt_pk_bf16_f32 v101, v78, v79
    v_cvt_pk_bf16_f32 v96, v72, v73
    v_cvt_pk_bf16_f32 v97, v74, v75
    v_fmac_f32 v104, v32, v64
    v_fmac_f32 v105, v33, v64
    v_fmac_f32 v108, v34, v64
    v_fmac_f32 v104, v36, v65
    v_fmac_f32 v105, v37, v65
    v_fmac_f32 v108, v38, v65
    v_fmac_f32 v104, v40, v66
    v_fmac_f32 v105, v41, v66
    v_fmac_f32 v108, v42, v66
    v_fmac_f32 v104, v44, v67
    v_fmac_f32 v105, v45, v67
    v_fmac_f32 v108, v46, v67
    v_add_u32 v14, 128, v14
    v_add_u32 v15, 256, v15
    v_add_u32 v16, v11, v16
    s_waitcnt lgkmcnt(0)
    v_mfma_f32_16x16x16_bf16 v[68:71], v[82:83], v[86:87], 0
    v_mfma_f32_16x16x16_bf16 v[76:79], v[82:83], v[90:91], 0
    v_mfma_f32_16x16x16_bf16 v[72:75], v[82:83], v[88:89], 0
    v_mfma_f32_16x16x16_bf16 v[64:67], v[82:83], v[84:85], 0
    s_sub_u32 s89, s89, 1
    s_cmp_eq_u32 s89, 0
    s_cbranch_scc1 V_LAST1
    v_add_u32 v24, v24, v5
    v_add_u32 v25, v25, v5
    v_add_u32 v26, v26, v5
    v_add_u32 v27, v27, v5
    v_add_u32 v20, v20, v8
    ds_read_b64 v[80:81], v20
    s_cmp_eq_u32 s89, 1
    s_cbranch_scc1 V_BP1
V_BF1:
    buffer_load_dwordx4 v[32:35], v24, s[4:7], 0 offen sc1
    buffer_load_dwordx4 v[36:39], v25, s[4:7], 0 offen sc1
    buffer_load_dwordx4 v[40:43], v26, s[4:7], 0 offen sc1
    buffer_load_dwordx4 v[44:47], v27, s[4:7], 0 offen sc1
    ds_read_b128 v[28:31], v14 offset:64
    ds_read_u16 v21, v15 offset:128
    s_waitcnt vmcnt(4)
V_BJ1:
    v_fmac_f32 v106, v48, v68
    v_fmac_f32 v107, v49, v68
    v_fmac_f32 v109, v50, v68
    v_mul_f32 v76, v51, v76
    v_lshlrev_b32 v48, 16, v48
    v_lshlrev_b32 v49, 16, v49
    v_lshlrev_b32 v50, 16, v50
    v_lshlrev_b32 v51, 16, v51
    v_fmac_f32 v106, v52, v69
    v_fmac_f32 v107, v53, v69
    v_fmac_f32 v109, v54, v69
    v_mul_f32 v77, v55, v77
    v_lshlrev_b32 v52, 16, v52
    v_lshlrev_b32 v53, 16, v53
    v_lshlrev_b32 v54, 16, v54
    v_lshlrev_b32 v55, 16, v55
    v_fmac_f32 v106, v56, v70
    v_fmac_f32 v107, v57, v70
    v_fmac_f32 v109, v58, v70
    v_mul_f32 v78, v59, v78
    v_lshlrev_b32 v56, 16, v56
    v_lshlrev_b32 v57, 16, v57
    v_lshlrev_b32 v58, 16, v58
    v_lshlrev_b32 v59, 16, v59
    v_fmac_f32 v106, v60, v71
    v_fmac_f32 v107, v61, v71
    v_fmac_f32 v109, v62, v71
    v_mul_f32 v79, v63, v79
    v_lshlrev_b32 v60, 16, v60
    v_lshlrev_b32 v61, 16, v61
    v_lshlrev_b32 v62, 16, v62
    v_lshlrev_b32 v63, 16, v63
    v_mul_f32 v72, v51, v72
    v_mul_f32 v73, v55, v73
    v_mul_f32 v74, v59, v74
    v_mul_f32 v75, v63, v75
    v_cvt_pk_bf16_f32 v102, v76, v77
    v_cvt_pk_bf16_f32 v103, v78, v79
    v_cvt_pk_bf16_f32 v98, v72, v73
    v_cvt_pk_bf16_f32 v99, v74, v75
    v_fmac_f32 v104, v48, v64
    v_fmac_f32 v105, v49, v64
    v_fmac_f32 v108, v50, v64
    v_mfma_f32_16x16x32_bf16 v[116:119], v[92:95], v[100:103], v[116:119]
    v_fmac_f32 v104, v52, v65
    v_fmac_f32 v105, v53, v65
    v_fmac_f32 v108, v54, v65
    v_mfma_f32_16x16x32_bf16 v[112:115], v[92:95], v[96:99], v[112:115]
    v_fmac_f32 v104, v56, v66
    v_fmac_f32 v105, v57, v66
    v_fmac_f32 v108, v58, v66
    v_fmac_f32 v104, v60, v67
    v_fmac_f32 v105, v61, v67
    v_fmac_f32 v108, v62, v67
    s_branch V_LOOP
V_BP0:
    s_cmp_eq_u32 s93, 4
    s_cbranch_scc1 V_BF0
    buffer_load_dwordx4 v[48:51], v28, s[4:7], 0 offen sc1
    s_cmp_lg_u32 s93, 1
    s_cbranch_scc1 V_BQ00
    s_waitcnt vmcnt(1)
    s_branch V_BJ0
V_BQ00:
    buffer_load_dwordx4 v[52:55], v29, s[4:7], 0 offen sc1
    s_cmp_lg_u32 s93, 2
    s_cbranch_scc1 V_BQ01
    s_waitcnt vmcnt(2)
    s_branch V_BJ0
V_BQ01:
    buffer_load_dwordx4 v[56:59], v30, s[4:7], 0 offen sc1
    s_waitcnt vmcnt(3)
    s_branch V_BJ0
V_BP1:
    s_cmp_eq_u32 s93, 4
    s_cbranch_scc1 V_BF1
    buffer_load_dwordx4 v[32:35], v24, s[4:7], 0 offen sc1
    s_cmp_lg_u32 s93, 1
    s_cbranch_scc1 V_BQ10
    s_waitcnt vmcnt(1)
    s_branch V_BJ1
V_BQ10:
    buffer_load_dwordx4 v[36:39], v25, s[4:7], 0 offen sc1
    s_cmp_lg_u32 s93, 2
    s_cbranch_scc1 V_BQ11
    s_waitcnt vmcnt(2)
    s_branch V_BJ1
V_BQ11:
    buffer_load_dwordx4 v[40:43], v26, s[4:7], 0 offen sc1
    s_waitcnt vmcnt(3)
    s_branch V_BJ1
V_LAST0:
    s_waitcnt vmcnt(0)
    s_nop 3
    v_fmac_f32 v106, v32, v68
    v_fmac_f32 v107, v33, v68
    v_fmac_f32 v109, v34, v68
    v_mul_f32 v76, v35, v76
    v_lshlrev_b32 v32, 16, v32
    v_lshlrev_b32 v33, 16, v33
    v_lshlrev_b32 v34, 16, v34
    v_lshlrev_b32 v35, 16, v35
    v_fmac_f32 v104, v32, v64
    v_fmac_f32 v105, v33, v64
    v_fmac_f32 v108, v34, v64
    v_mul_f32 v72, v35, v72
    s_cmp_eq_u32 s93, 1
    s_cbranch_scc1 V_LT0
    v_fmac_f32 v106, v36, v69
    v_fmac_f32 v107, v37, v69
    v_fmac_f32 v109, v38, v69
    v_mul_f32 v77, v39, v77
    v_lshlrev_b32 v36, 16, v36
    v_lshlrev_b32 v37, 16, v37
    v_lshlrev_b32 v38, 16, v38
    v_lshlrev_b32 v39, 16, v39
    v_fmac_f32 v104, v36, v65
    v_fmac_f32 v105, v37, v65
    v_fmac_f32 v108, v38, v65
    v_mul_f32 v73, v39, v73
    s_cmp_eq_u32 s93, 2
    s_cbranch_scc1 V_LT0
    v_fmac_f32 v106, v40, v70
    v_fmac_f32 v107, v41, v70
    v_fmac_f32 v109, v42, v70
    v_mul_f32 v78, v43, v78
    v_lshlrev_b32 v40, 16, v40
    v_lshlrev_b32 v41, 16, v41
    v_lshlrev_b32 v42, 16, v42
    v_lshlrev_b32 v43, 16, v43
    v_fmac_f32 v104, v40, v66
    v_fmac_f32 v105, v41, v66
    v_fmac_f32 v108, v42, v66
    v_mul_f32 v74, v43, v74
    s_cmp_eq_u32 s93, 3
    s_cbranch_scc1 V_LT0
    v_fmac_f32 v106, v44, v71
    v_fmac_f32 v107, v45, v71
    v_fmac_f32 v109, v46, v71
    v_mul_f32 v79, v47, v79
    v_lshlrev_b32 v44, 16, v44
    v_lshlrev_b32 v45, 16, v45
    v_lshlrev_b32 v46, 16, v46
    v_lshlrev_b32 v47, 16, v47
    v_fmac_f32 v104, v44, v67
    v_fmac_f32 v105, v45, v67
    v_fmac_f32 v108, v46, v67
    v_mul_f32 v75, v47, v75
V_LT0:
    v_cvt_pk_bf16_f32 v100, v76, v77
    v_cvt_pk_bf16_f32 v101, v78, v79
    v_cvt_pk_bf16_f32 v96, v72, v73
    v_cvt_pk_bf16_f32 v97, v74, v75
    s_waitcnt lgkmcnt(0)
    v_mfma_f32_16x16x16_bf16 v[116:119], v[92:93], v[100:101], v[116:119]
    v_mfma_f32_16x16x16_bf16 v[112:115], v[92:93], v[96:97], v[112:115]
    s_nop 7
    s_branch V_EPI
V_LAST1:
    s_waitcnt vmcnt(0)
    s_nop 3
    v_fmac_f32 v106, v48, v68
    v_fmac_f32 v107, v49, v68
    v_fmac_f32 v109, v50, v68
    v_mul_f32 v76, v51, v76
    v_lshlrev_b32 v48, 16, v48
    v_lshlrev_b32 v49, 16, v49
    v_lshlrev_b32 v50, 16, v50
    v_lshlrev_b32 v51, 16, v51
    v_fmac_f32 v104, v48, v64
    v_fmac_f32 v105, v49, v64
    v_fmac_f32 v108, v50, v64
    v_mul_f32 v72, v51, v72
    s_cmp_eq_u32 s93, 1
    s_cbranch_scc1 V_LT1
    v_fmac_f32 v106, v52, v69
    v_fmac_f32 v107, v53, v69
    v_fmac_f32 v109, v54, v69
    v_mul_f32 v77, v55, v77
    v_lshlrev_b32 v52, 16, v52
    v_lshlrev_b32 v53, 16, v53
    v_lshlrev_b32 v54, 16, v54
    v_lshlrev_b32 v55, 16, v55
    v_fmac_f32 v104, v52, v65
    v_fmac_f32 v105, v53, v65
    v_fmac_f32 v108, v54, v65
    v_mul_f32 v73, v55, v73
    s_cmp_eq_u32 s93, 2
    s_cbranch_scc1 V_LT1
    v_fmac_f32 v106, v56, v70
    v_fmac_f32 v107, v57, v70
    v_fmac_f32 v109, v58, v70
    v_mul_f32 v78, v59, v78
    v_lshlrev_b32 v56, 16, v56
    v_lshlrev_b32 v57, 16, v57
    v_lshlrev_b32 v58, 16, v58
    v_lshlrev_b32 v59, 16, v59
    v_fmac_f32 v104, v56, v66
    v_fmac_f32 v105, v57, v66
    v_fmac_f32 v108, v58, v66
    v_mul_f32 v74, v59, v74
    s_cmp_eq_u32 s93, 3
    s_cbranch_scc1 V_LT1
    v_fmac_f32 v106, v60, v71
    v_fmac_f32 v107, v61, v71
    v_fmac_f32 v109, v62, v71
    v_mul_f32 v79, v63, v79
    v_lshlrev_b32 v60, 16, v60
    v_lshlrev_b32 v61, 16, v61
    v_lshlrev_b32 v62, 16, v62
    v_lshlrev_b32 v63, 16, v63
    v_fmac_f32 v104, v60, v67
    v_fmac_f32 v105, v61, v67
    v_fmac_f32 v108, v62, v67
    v_mul_f32 v75, v63, v75
V_LT1:
    v_cvt_pk_bf16_f32 v102, v76, v77
    v_cvt_pk_bf16_f32 v103, v78, v79
    v_cvt_pk_bf16_f32 v98, v72, v73
    v_cvt_pk_bf16_f32 v99, v74, v75
    s_waitcnt lgkmcnt(0)
    v_mfma_f32_16x16x32_bf16 v[116:119], v[92:95], v[100:103], v[116:119]
    v_mfma_f32_16x16x32_bf16 v[112:115], v[92:95], v[96:99], v[112:115]
    s_nop 7
V_EPI:
    v_add_f32 v104, v104, v112
    v_add_f32 v106, v106, v116
    v_add_f32 v105, v105, v113
    v_add_f32 v107, v107, v117
    v_add_f32 v108, v108, v114
    v_add_f32 v109, v109, v118
    s_cmp_eq_u32 s53, 0
    s_cbranch_scc1 V_FIN
    v_lshlrev_b32 v18, 1, v17
    s_cmp_lg_u32 s54, 0
    s_cbranch_scc1 V_NOLD
    buffer_load_dwordx2 v[32:33], v18, s[28:31], 0 offen offset:512 sc0 sc1
    buffer_load_dwordx2 v[34:35], v18, s[28:31], 0 offen offset:1024 sc0 sc1
    buffer_load_dwordx2 v[36:37], v18, s[28:31], 0 offen offset:1536 sc0 sc1
    s_waitcnt vmcnt(0)
    v_add_f32 v104, v104, v32
    v_add_f32 v106, v106, v33
    v_add_f32 v105, v105, v34
    v_add_f32 v107, v107, v35
    v_add_f32 v108, v108, v36
    v_add_f32 v109, v109, v37
V_NOLD:
    s_cmp_lg_u32 s55, 0
    s_cbranch_scc1 V_FIN
    v_mov_b32 v32, v104
    v_mov_b32 v33, v106
    buffer_store_dwordx2 v[32:33], v18, s[28:31], 0 offen offset:512 sc0 sc1
    v_mov_b32 v34, v105
    v_mov_b32 v35, v107
    buffer_store_dwordx2 v[34:35], v18, s[28:31], 0 offen offset:1024 sc0 sc1
    v_mov_b32 v36, v108
    v_mov_b32 v37, v109
    buffer_store_dwordx2 v[36:37], v18, s[28:31], 0 offen offset:1536 sc0 sc1
    s_waitcnt vmcnt(0)
    s_branch V_NEXT
V_FIN:
    s_waitcnt lgkmcnt(0)
    v_cvt_pk_bf16_f32 v104, 0, v104
    v_cvt_pk_bf16_f32 v106, 0, v106
    v_lshlrev_b32 v18, 16, v120
    v_and_b32 v19, 0xffff0000, v120
    v_add_f32 v104, v104, v18
    v_add_f32 v106, v106, v19
    v_cvt_pk_bf16_f32 v64, v104, v106
    buffer_store_dword v64, v17, s[16:19], 0 offen offset:256 nt
    v_cvt_pk_bf16_f32 v105, 0, v105
    v_cvt_pk_bf16_f32 v107, 0, v107
    v_lshlrev_b32 v18, 16, v121
    v_and_b32 v19, 0xffff0000, v121
    v_add_f32 v105, v105, v18
    v_add_f32 v107, v107, v19
    v_cvt_pk_bf16_f32 v65, v105, v107
    buffer_store_dword v65, v17, s[16:19], 0 offen offset:512 nt
    v_cvt_pk_bf16_f32 v108, 0, v108
    v_cvt_pk_bf16_f32 v109, 0, v109
    v_lshlrev_b32 v18, 16, v122
    v_and_b32 v19, 0xffff0000, v122
    v_add_f32 v108, v108, v18
    v_add_f32 v109, v109, v19
    v_cvt_pk_bf16_f32 v66, v108, v109
    buffer_store_dword v66, v17, s[16:19], 0 offen offset:768 nt
    s_branch V_NEXT
V_DONE:
    s_cmp_lg_u32 s55, 0
    s_cbranch_scc1 K_FIN
    s_add_u32 s51, s51, s52
    s_mov_b32 s54, 0
    s_branch K_AGAIN
K_FIN:
K_END:
    s_endpgm
CODE1:
.section .rodata,"a"
.p2align 6
.amdhsa_kernel standalone__molecular_angular_painn__graph_kernel
  .amdhsa_next_free_vgpr 128
  .amdhsa_next_free_sgpr 102
  .amdhsa_accum_offset 128
  .amdhsa_group_segment_fixed_size 0
  .amdhsa_kernarg_size 88
  .amdhsa_user_sgpr_count 2
  .amdhsa_user_sgpr_kernarg_segment_ptr 1
  .amdhsa_system_sgpr_workgroup_id_x 1
  .amdhsa_float_denorm_mode_32 3
.end_amdhsa_kernel
```
